```python
import torch

def _softmax(x, axis=-1):
    return torch.softmax(x, dim=axis)
def _gelu(x):
    return torch.nn.functional.gelu(x, approximate="tanh")
def _silu(x):
    return torch.nn.functional.silu(x)
def _sigmoid(x):
    return torch.sigmoid(x)
def _layernorm(x, axis=-1, eps=1e-5):
    m = x.mean(dim=axis, keepdim=True)
    v = x.var(dim=axis, keepdim=True, unbiased=False)
    return (x - m) / torch.sqrt(v + eps)
def _scatter_add(tgt, idx, src, axis=0):
    return tgt.clone().index_add_(axis, idx, src)
def _segment_sum(src, seg, n):
    out = torch.zeros((n,) + src.shape[1:], dtype=src.dtype)
    return out.index_add_(0, seg, src)
def _pad(x, pw):
    flat = tuple(v for pair in reversed(pw) for v in pair)
    return torch.nn.functional.pad(x, flat)

kernel_name = 'standalone__deep_cross_pnn__recsys'

def setup_inputs():

    _w = (lambda a: (lambda t: t.to(torch.bfloat16) if t.is_floating_point() else t)(torch.as_tensor(a)))
    B, F, D, V = 4096, 100, 128, min(1000, 100000)
    H = 4 * D
    return {
        "idx": _w((lambda lo, hi, *s: torch.randint(lo, hi, s))(0, V, B, F).to(torch.int64)),
        "table": _w((lambda *s: torch.randn(*s, dtype=torch.bfloat16) * 1.6)(V, D) * (D ** -0.5)),
        "w_p": _w((lambda *s: torch.randn(*s, dtype=torch.bfloat16) * 0.05)(F * F) * ((F * F) ** -0.5)),
        "w1": _w((lambda *s: torch.randn(*s, dtype=torch.bfloat16) * 1.6)(F * D, H) * ((F * D) ** -0.5)),
        "b1": _w((lambda *s: torch.randn(*s, dtype=torch.bfloat16) * 6.4)(H) * 0.01),
        "w2": _w((lambda *s: torch.randn(*s, dtype=torch.bfloat16) * 0.05)(H) * (H ** -0.5)),
        "b2": _w((lambda *s: torch.randn(*s, dtype=torch.bfloat16) * 0.8)(1) * 0.01),
    }

def reference(idx, table, w_p, w1, b1, w2, b2):
    emb = table[idx]
    B = emb.shape[0]; F = emb.shape[1]; D = emb.shape[2]
    ip = torch.einsum('bid,bjd->bij', emb, emb)
    ip = ip.reshape(B, F * F)
    logit_p = ip @ w_p
    z = emb.reshape(B, F * D)
    h = _gelu(z @ w1 + b1)
    logit_d = h @ w2 + b2
    return logit_p + logit_d
```

```asm
; @launch grid=(256,1,1) block=(256,1,1) lds=163840
.amdgcn_target "amdgcn-amd-amdhsa--gfx950"
.text
.globl standalone__deep_cross_pnn__recsys_kernel
.p2align 8
.type standalone__deep_cross_pnn__recsys_kernel,@function
standalone__deep_cross_pnn__recsys_kernel:
    s_cmp_ge_u32 s2, 256
    s_cbranch_scc1 L_end
    s_load_dwordx16 s[4:19], s[0:1], 0
    s_load_dwordx4 s[20:23], s[0:1], 64
    s_getpc_b64 s[96:97]
    v_lshrrev_b32 v1, 6, v0
    s_nop 0
    v_readfirstlane_b32 s48, v1
    s_and_b32 s96, s96, 0xffffff00
    s_lshr_b32 s51, s2, 3
    s_mul_i32 s51, s51, 1280
    v_lshlrev_b32 v64, 7, v0
    v_add_u32 v64, s51, v64
    v_min_u32 v64, L_end-standalone__deep_cross_pnn__recsys_kernel, v64
    v_cmp_gt_u32 vcc, 10, v0
    s_nop 0
    s_and_saveexec_b64 s[98:99], vcc
    s_cbranch_execz L_nocpf
    global_load_dword v254, v64, s[96:97]
L_nocpf:
    s_mov_b64 exec, -1
    s_and_b32 s51, s2, 7
    s_lshl_b32 s51, s51, 4
    s_bfe_u32 s52, s2, 0x40004
    s_add_u32 s49, s51, s52
    s_bfe_u32 s50, s2, 0x10003
    v_and_b32 v2, 63, v0
    v_lshlrev_b32 v2, 4, v2
    v_lshrrev_b32 v14, 7, v2
    v_bfe_u32 v3, v2, 4, 3
    v_xor_b32 v3, v3, v14
    v_lshlrev_b32 v3, 4, v3
    v_lshl_add_u32 v3, v14, 8, v3
    s_lshr_b32 s3, s2, 3
    s_lshl_b32 s3, s3, 16
    s_and_b32 s54, s2, 7
    s_lshl_b32 s54, s54, 7
    s_add_u32 s3, s3, s54
    v_and_b32 v249, 31, v0
    v_bfe_u32 v65, v0, 6, 1
    v_lshl_add_u32 v249, v65, 5, v249
    v_lshlrev_b32 v249, 10, v249
    v_lshrrev_b32 v65, 7, v0
    s_mov_b32 s53, 6291456
    v_mul_lo_u32 v65, v65, s53
    v_add_u32 v249, v249, v65
    v_bfe_u32 v65, v0, 5, 1
    v_lshl_add_u32 v249, v65, 30, v249
    s_lshr_b32 s53, s2, 3
    s_lshl_b32 s53, s53, 14
    s_add_u32 s53, s53, s54
    s_add_u32 s53, s53, 12582912
    v_lshlrev_b32 v66, 10, v0
    v_cmp_le_u32 vcc, 16, v0
    v_mov_b32 v65, 0x40000000
    s_nop 0
    v_cndmask_b32 v66, v66, v65, vcc
    s_waitcnt lgkmcnt(0)
    s_mov_b32 s24, s6
    s_and_b32 s25, s7, 0xffff
    s_mov_b32 s26, 256000
    s_mov_b32 s27, 0x00020000
    s_mov_b32 s28, s10
    s_and_b32 s29, s11, 0xffff
    s_mov_b32 s30, 13107200
    s_mov_b32 s31, 0x00020000
    s_cmp_lg_u32 s48, 0
    s_cbranch_scc1 L_notpf
    s_lshr_b32 s51, s2, 3
    s_lshl_b32 s51, s51, 13
    v_lshlrev_b32 v64, 7, v0
    buffer_load_dword v253, v64, s[24:27], s51 offen
    buffer_load_dword v251, v66, s[28:31], s53 offen
L_notpf:
    s_mov_b32 s36, s4
    s_and_b32 s37, s5, 0xffff
    s_mov_b32 s38, 1638400
    s_mov_b32 s39, 0x00020000
    s_mul_i32 s51, s2, 6400
    s_lshl_b32 s52, s48, 10
    s_add_u32 m0, s52, 155648
    s_add_u32 s51, s51, s52
    buffer_load_dwordx4 v2, s[36:39], s51 offen lds
    s_add_u32 m0, m0, 4096
    s_add_u32 s51, s51, 4096
    buffer_load_dwordx4 v2, s[36:39], s51 offen lds
    s_mov_b32 s40, s8
    s_and_b32 s41, s9, 0xffff
    s_mov_b32 s42, 20000
    s_mov_b32 s43, 0x00020000
    s_mul_i32 s51, s48, 6144
    s_add_u32 s51, s51, 0
    s_add_u32 m0, s51, 131072
    s_nop 0
    buffer_load_dwordx4 v2, s[40:43], s51 offen lds
    s_mul_i32 s51, s48, 6144
    s_add_u32 s51, s51, 1024
    s_add_u32 m0, s51, 131072
    s_nop 0
    buffer_load_dwordx4 v2, s[40:43], s51 offen lds
    s_mul_i32 s51, s48, 6144
    s_add_u32 s51, s51, 2048
    s_add_u32 m0, s51, 131072
    s_nop 0
    buffer_load_dwordx4 v2, s[40:43], s51 offen lds
    s_mul_i32 s51, s48, 6144
    s_add_u32 s51, s51, 3072
    s_add_u32 m0, s51, 131072
    s_nop 0
    buffer_load_dwordx4 v2, s[40:43], s51 offen lds
    s_mul_i32 s51, s48, 6144
    s_add_u32 s51, s51, 4096
    s_add_u32 m0, s51, 131072
    s_nop 0
    buffer_load_dwordx4 v2, s[40:43], s51 offen lds
    s_mul_i32 s51, s48, 6144
    s_add_u32 s51, s51, 5120
    s_add_u32 m0, s51, 131072
    s_nop 0
    buffer_load_dwordx4 v2, s[40:43], s51 offen lds
    s_mov_b32 s32, s22
    s_and_b32 s33, s23, 0xffff
    s_mov_b32 s34, 268435456
    s_mov_b32 s35, 0x00020000
    s_mul_i32 s65, s2, 41984
    s_add_u32 s65, s65, 1048576
    s_add_u32 s53, s65, 32768
    s_add_u32 s54, s53, 4096
    v_mov_b32 v100, -1
    v_mov_b32 v101, -1
    v_mov_b32 v102, -1
    v_mov_b32 v103, -1
    v_lshlrev_b32 v104, 4, v0
    buffer_store_dwordx4 v[100:103], v104, s[32:35], s53 offen sc1
    buffer_store_dwordx4 v[100:103], v104, s[32:35], s54 offen sc1
    s_lshl_b32 s54, s48, 7
    s_add_u32 s78, s65, s54
    s_add_u32 s78, s78, 40960
    v_lshlrev_b32 v104, 24, v2
    buffer_store_dword v100, v104, s[32:35], s78 offen sc1
    s_lshl_b32 s51, s49, 3
    s_add_u32 s12, s12, s51
    s_addc_u32 s13, s13, 0
    s_add_u32 s14, s14, s51
    s_addc_u32 s15, s15, 0
    s_load_dwordx2 s[68:69], s[12:13], 0
    s_load_dwordx2 s[72:73], s[14:15], 0
    s_load_dword s76, s[16:17], 0
    s_lshl_b32 s67, s48, 16
    s_lshl_b32 s61, s48, 15
    v_and_b32 v200, 15, v0
    v_lshrrev_b32 v201, 4, v0
    v_cmp_le_u32 vcc, 6, v201
    s_nop 1
    v_cndmask_b32 v202, 0, 1, vcc
    v_mul_u32_u24 v203, 6, v202
    v_sub_u32 v203, v201, v203
    v_cmp_le_u32 vcc, 12, v201
    s_add_u32 m0, s61, 0
    s_add_u32 s51, s67, 128
    buffer_load_dwordx4 v3, s[24:27], s51 offen lds
    v_cndmask_b32 v204, 7, 3, vcc
    v_min_u32 v203, 6, v203
    v_cndmask_b32 v205, 3, 2, vcc
    v_cndmask_b32 v199, 0, 2, vcc
    v_and_b32 v207, 1, v203
    v_cndmask_b32 v207, v207, 1, vcc
    s_add_u32 m0, s61, 1024
    s_add_u32 s51, s67, 2176
    buffer_load_dwordx4 v3, s[24:27], s51 offen lds
    v_lshlrev_b32 v207, 13, v207
    v_lshlrev_b32 v206, 3, v203
    v_mad_u32_u24 v206, v202, 48, v206
    v_lshlrev_b32 v206, 2, v206
    s_movk_i32 s54, 400
    v_mad_u32_u24 v206, v200, s54, v206
    s_add_u32 m0, s61, 2048
    s_add_u32 s51, s67, 4224
    buffer_load_dwordx4 v3, s[24:27], s51 offen lds
    v_add_u32 v206, 155648, v206
    v_add_u32 v16, 0, v200
    v_and_b32 v16, v16, v204
    v_lshl_add_u32 v24, v16, 2, v206
    v_or_b32 v16, v16, v207
    v_add_u32 v17, 1, v200
    s_add_u32 m0, s61, 3072
    s_add_u32 s51, s67, 6272
    buffer_load_dwordx4 v3, s[24:27], s51 offen lds
    v_and_b32 v17, v17, v204
    v_lshl_add_u32 v25, v17, 2, v206
    v_or_b32 v17, v17, v207
    v_add_u32 v18, 2, v200
    v_and_b32 v18, v18, v204
    v_lshl_add_u32 v26, v18, 2, v206
    s_add_u32 m0, s61, 4096
    s_add_u32 s51, s67, 8320
    buffer_load_dwordx4 v3, s[24:27], s51 offen lds
    v_or_b32 v18, v18, v207
    v_add_u32 v19, 3, v200
    v_and_b32 v19, v19, v204
    v_lshl_add_u32 v27, v19, 2, v206
    v_or_b32 v19, v19, v207
    v_add_u32 v20, 4, v200
    v_and_b32 v20, v20, v204
    s_add_u32 m0, s61, 5120
    s_add_u32 s51, s67, 10368
    buffer_load_dwordx4 v3, s[24:27], s51 offen lds
    v_lshl_add_u32 v28, v20, 2, v206
    v_or_b32 v20, v20, v207
    v_add_u32 v21, 5, v200
    v_and_b32 v21, v21, v204
    v_lshl_add_u32 v29, v21, 2, v206
    v_or_b32 v21, v21, v207
    s_add_u32 m0, s61, 6144
    s_add_u32 s51, s67, 12416
    buffer_load_dwordx4 v3, s[24:27], s51 offen lds
    v_add_u32 v22, 6, v200
    v_and_b32 v22, v22, v204
    v_lshl_add_u32 v30, v22, 2, v206
    v_or_b32 v22, v22, v207
    v_add_u32 v23, 7, v200
    v_and_b32 v23, v23, v204
    s_add_u32 m0, s61, 7168
    s_add_u32 s51, s67, 14464
    buffer_load_dwordx4 v3, s[24:27], s51 offen lds
    v_lshl_add_u32 v31, v23, 2, v206
    v_or_b32 v23, v23, v207
    v_and_b32 v220, 15, v0
    v_bfe_u32 v221, v0, 4, 2
    s_movk_i32 s54, 200
    v_mul_lo_u32 v223, v220, s54
    s_add_u32 m0, s61, 8192
    s_add_u32 s51, s67, 16512
    buffer_load_dwordx4 v3, s[24:27], s51 offen lds
    v_lshl_add_u32 v223, v221, 4, v223
    v_add_u32 v223, 131072, v223
    v_lshrrev_b32 v226, 2, v220
    v_mul_lo_u32 v240, v226, s54
    v_lshl_add_u32 v240, v221, 4, v240
    v_add_u32 v240, 131072, v240
    s_add_u32 m0, s61, 9216
    s_add_u32 s51, s67, 18560
    buffer_load_dwordx4 v3, s[24:27], s51 offen lds
    v_mov_b32 v236, 0
    v_mov_b32 v237, 0
    v_mov_b32 v238, 0
    v_mov_b32 v239, 0
    s_movk_i32 s54, 0x3f80
    v_writelane_b32 v236, s54, 0
    v_writelane_b32 v237, s54, 8
    s_mov_b32 s54, 0x3f800000
    v_writelane_b32 v236, s54, 4
    v_writelane_b32 v237, s54, 12
    v_and_b32 v226, 1, v220
    s_add_u32 m0, s61, 10240
    s_add_u32 s51, s67, 20608
    buffer_load_dwordx4 v3, s[24:27], s51 offen lds
    v_lshlrev_b32 v226, 4, v226
    v_mov_b32 v227, 0x3f80
    v_lshlrev_b32 v227, v226, v227
    v_lshrrev_b32 v226, 1, v220
    v_lshlrev_b32 v228, 2, v221
    v_sub_u32 v226, v226, v228
    v_cmp_eq_u32 vcc, 0, v226
    s_add_u32 m0, s61, 11264
    s_add_u32 s51, s67, 22656
    buffer_load_dwordx4 v3, s[24:27], s51 offen lds
    v_cndmask_b32 v228, 0, v227, vcc
    v_cmp_eq_u32 vcc, -8, v226
    s_nop 1
    v_cndmask_b32 v232, 0, v227, vcc
    v_cmp_eq_u32 vcc, 1, v226
    s_nop 1
    v_cndmask_b32 v229, 0, v227, vcc
    v_cmp_eq_u32 vcc, -7, v226
    s_add_u32 m0, s61, 12288
    s_add_u32 s51, s67, 24704
    buffer_load_dwordx4 v3, s[24:27], s51 offen lds
    v_cndmask_b32 v233, 0, v227, vcc
    v_cmp_eq_u32 vcc, 2, v226
    s_nop 1
    v_cndmask_b32 v230, 0, v227, vcc
    v_cmp_eq_u32 vcc, -6, v226
    s_nop 1
    v_cndmask_b32 v234, 0, v227, vcc
    v_cmp_eq_u32 vcc, 3, v226
    s_add_u32 m0, s61, 13312
    s_add_u32 s51, s67, 26752
    buffer_load_dwordx4 v3, s[24:27], s51 offen lds
    v_cndmask_b32 v231, 0, v227, vcc
    v_cmp_eq_u32 vcc, -5, v226
    s_nop 1
    v_cndmask_b32 v235, 0, v227, vcc
    s_mul_i32 s54, s48, 1600
    s_add_u32 s54, s54, 155648
    v_lshl_add_u32 v224, v220, 2, s54
    s_add_u32 m0, s61, 14336
    s_add_u32 s51, s67, 28800
    buffer_load_dwordx4 v3, s[24:27], s51 offen lds
    v_and_b32 v241, 12, v220
    v_add_u32 v241, s54, v241
    v_cmp_eq_u32 vcc, 3, v204
    s_lshr_b32 s54, s2, 7
    v_mov_b32 v209, s54
    v_cndmask_b32 v210, v202, v209, vcc
    s_add_u32 m0, s61, 15360
    s_add_u32 s51, s67, 30848
    buffer_load_dwordx4 v3, s[24:27], s51 offen lds
    v_lshlrev_b32 v211, 4, v203
    v_add_u32 v211, 4, v211
    v_cndmask_b32 v208, v211, 0, vcc
    v_cndmask_b32 v211, 8, 0, vcc
    v_cmp_eq_u32 vcc, v209, v202
    s_nop 1
    v_cndmask_b32 v211, 0, v211, vcc
    s_add_u32 m0, s61, 16384
    s_add_u32 s51, s67, 32896
    buffer_load_dwordx4 v3, s[24:27], s51 offen lds
    v_add_u32 v208, v208, v211
    s_movk_i32 s54, 400
    v_mad_u32_u24 v208, v210, s54, v208
    v_lshlrev_b32 v208, 10, v208
    v_lshl_add_u32 v208, v200, 4, v208
    v_cmp_le_u32 vcc, 12, v201
    v_mov_b32 v211, 0x7ff00000
    s_add_u32 m0, s61, 17408
    s_add_u32 s51, s67, 34944
    buffer_load_dwordx4 v3, s[24:27], s51 offen lds
    v_cndmask_b32 v198, v208, v211, vcc
    v_cmp_eq_u32 vcc, 12, v201
    s_nop 1
    v_cndmask_b32 v208, v211, v208, vcc
    s_bfe_u32 s52, s2, 0x20005
    s_mul_i32 s52, s52, 102400
    s_bfe_u32 s54, s2, 0x20003
    s_add_u32 m0, s61, 18432
    s_add_u32 s51, s67, 36992
    buffer_load_dwordx4 v3, s[24:27], s51 offen lds
    s_lshl_b32 s54, s54, 10
    s_add_u32 s52, s52, s54
    s_bfe_u32 s54, s2, 0x10002
    s_lshl_b32 s54, s54, 3
    s_add_u32 s52, s52, s54
    s_and_b32 s54, s2, 3
    s_add_u32 m0, s61, 19456
    s_add_u32 s51, s67, 39040
    buffer_load_dwordx4 v3, s[24:27], s51 offen lds
    s_lshl_b32 s54, s54, 8
    s_add_u32 s52, s52, s54
    s_bfe_u32 s53, s2, 0x20005
    s_mul_i32 s53, s53, 102400
    s_bfe_u32 s54, s2, 0x30002
    s_lshl_b32 s54, s54, 10
    s_add_u32 m0, s61, 20480
    s_add_u32 s51, s67, 41088
    buffer_load_dwordx4 v3, s[24:27], s51 offen lds
    s_add_u32 s53, s53, s54
    s_and_b32 s54, s2, 3
    s_lshl_b32 s54, s54, 8
    s_add_u32 s53, s53, s54
    s_lshl_b32 s54, s48, 15
    v_and_b32 v222, 3, v220
    s_add_u32 m0, s61, 21504
    s_add_u32 s51, s67, 43136
    buffer_load_dwordx4 v3, s[24:27], s51 offen lds
    v_lshlrev_b32 v222, 2, v222
    v_lshrrev_b32 v244, 2, v220
    v_add_u32 v222, v222, v244
    v_and_b32 v244, 7, v222
    v_xor_b32 v244, v244, v221
    v_lshlrev_b32 v244, 4, v244
    v_lshl_add_u32 v244, v222, 7, v244
    s_add_u32 m0, s61, 22528
    s_add_u32 s51, s67, 45184
    buffer_load_dwordx4 v3, s[24:27], s51 offen lds
    v_add_u32 v244, s54, v244
    v_xor_b32 v245, 64, v244
    s_waitcnt vmcnt(26)
    s_barrier
    s_add_u32 m0, s61, 23552
    s_add_u32 s51, s67, 47232
    buffer_load_dwordx4 v3, s[24:27], s51 offen lds
    ds_read_b32 v172, v24
    ds_read_b32 v173, v25
    ds_read_b32 v174, v26
    ds_read_b32 v175, v27
    ds_read_b32 v176, v28
    ds_read_b32 v177, v29
    s_add_u32 m0, s61, 24576
    s_add_u32 s51, s67, 49280
    buffer_load_dwordx4 v3, s[24:27], s51 offen lds
    ds_read_b32 v178, v30
    ds_read_b32 v179, v31
    ds_read_b32 v144, v224 offset:0
    ds_read_b32 v145, v224 offset:64
    ds_read_b32 v146, v224 offset:128
    ds_read_b32 v147, v224 offset:192
    s_add_u32 m0, s61, 25600
    s_add_u32 s51, s67, 51328
    buffer_load_dwordx4 v3, s[24:27], s51 offen lds
    ds_read_b32 v148, v224 offset:256
    ds_read_b32 v149, v224 offset:320
    ds_read_b32 v150, v241 offset:384
    ds_read_b32 v151, v224 offset:400
    ds_read_b32 v152, v224 offset:464
    ds_read_b32 v153, v224 offset:528
    s_add_u32 m0, s61, 26624
    s_add_u32 s51, s67, 53376
    buffer_load_dwordx4 v3, s[24:27], s51 offen lds
    ds_read_b32 v154, v224 offset:592
    ds_read_b32 v155, v224 offset:656
    ds_read_b32 v156, v224 offset:720
    ds_read_b32 v157, v241 offset:784
    ds_read_b32 v158, v224 offset:800
    ds_read_b32 v159, v224 offset:864
    s_add_u32 m0, s61, 27648
    s_add_u32 s51, s67, 55424
    buffer_load_dwordx4 v3, s[24:27], s51 offen lds
    ds_read_b32 v160, v224 offset:928
    ds_read_b32 v161, v224 offset:992
    ds_read_b32 v162, v224 offset:1056
    ds_read_b32 v163, v224 offset:1120
    ds_read_b32 v164, v241 offset:1184
    ds_read_b32 v165, v224 offset:1200
    ds_read_b32 v166, v224 offset:1264
    s_add_u32 m0, s61, 28672
    s_add_u32 s51, s67, 57472
    buffer_load_dwordx4 v3, s[24:27], s51 offen lds
    ds_read_b32 v167, v224 offset:1328
    ds_read_b32 v168, v224 offset:1392
    ds_read_b32 v169, v224 offset:1456
    ds_read_b32 v170, v224 offset:1520
    ds_read_b32 v171, v241 offset:1584
    s_waitcnt lgkmcnt(15)
    s_add_u32 m0, s61, 29696
    s_add_u32 s51, s67, 59520
    buffer_load_dwordx4 v3, s[24:27], s51 offen lds
    v_bfe_u32 v24, v172, 2, v199
    v_xor_b32 v16, v16, v24
    v_lshl_add_u32 v172, v172, v205, v16
    v_bfe_u32 v25, v173, 2, v199
    v_xor_b32 v17, v17, v25
    v_lshl_add_u32 v173, v173, v205, v17
    s_add_u32 m0, s61, 30720
    s_add_u32 s51, s67, 61568
    buffer_load_dwordx4 v3, s[24:27], s51 offen lds
    v_bfe_u32 v26, v174, 2, v199
    v_xor_b32 v18, v18, v26
    v_lshl_add_u32 v174, v174, v205, v18
    v_bfe_u32 v27, v175, 2, v199
    v_xor_b32 v19, v19, v27
    v_lshl_add_u32 v175, v175, v205, v19
    s_add_u32 m0, s61, 31744
    s_add_u32 s51, s67, 63616
    buffer_load_dwordx4 v3, s[24:27], s51 offen lds
    v_bfe_u32 v28, v176, 2, v199
    v_xor_b32 v20, v20, v28
    v_lshl_add_u32 v176, v176, v205, v20
    v_bfe_u32 v29, v177, 2, v199
    v_xor_b32 v21, v21, v29
    v_lshl_add_u32 v177, v177, v205, v21
    s_waitcnt vmcnt(30)
    ds_read_b128 a[128:131], v244 offset:0
    ds_read_b128 a[132:135], v245 offset:0
    v_bfe_u32 v30, v178, 2, v199
    v_xor_b32 v22, v22, v30
    v_lshl_add_u32 v178, v178, v205, v22
    v_bfe_u32 v31, v179, 2, v199
    v_xor_b32 v23, v23, v31
    v_lshl_add_u32 v179, v179, v205, v23
    s_waitcnt vmcnt(28)
    ds_read_b128 a[136:139], v244 offset:2048
    ds_read_b128 a[140:143], v245 offset:2048
    v_lshl_or_b32 v24, v173, 16, v172
    v_lshl_or_b32 v25, v175, 16, v174
    v_lshl_or_b32 v26, v177, 16, v176
    v_lshl_or_b32 v27, v179, 16, v178
    buffer_store_dwordx4 v[24:27], v198, s[32:35], s53 offen sc1
    buffer_store_dwordx2 v[24:25], v208, s[32:35], s52 offen sc1
    v_and_b32 v225, 3, v220
    s_waitcnt vmcnt(28)
    ds_read_b128 a[144:147], v244 offset:4096
    ds_read_b128 a[148:151], v245 offset:4096
    v_cmp_eq_u32 vcc, 0, v225
    v_mov_b32 v225, 1000
    s_waitcnt lgkmcnt(6)
    ds_read_b64 a[0:1], v223 offset:0
    v_cndmask_b32 v150, v225, v150, vcc
    ds_read_b64 a[2:3], v223 offset:8
    s_waitcnt lgkmcnt(6)
    s_add_u32 m0, s61, 0
    s_add_u32 s51, s67, 0
    buffer_load_dwordx4 v3, s[24:27], s51 offen lds
    v_cndmask_b32 v157, v225, v157, vcc
    ds_read_b64 a[4:5], v223 offset:64
    v_cndmask_b32 v164, v225, v164, vcc
    ds_read_b64 a[6:7], v223 offset:72
    v_cndmask_b32 v171, v225, v171, vcc
    ds_read_b64 a[8:9], v223 offset:128
    s_add_u32 m0, s61, 1024
    s_add_u32 s51, s67, 2048
    buffer_load_dwordx4 v3, s[24:27], s51 offen lds
    v_xor_b32 v226, v144, v221
    ds_read_b64 a[10:11], v223 offset:136
    v_and_b32 v226, 7, v226
    ds_read_b64 a[12:13], v223 offset:192
    v_lshlrev_b32 v226, 4, v226
    ds_read_b64 a[14:15], v223 offset:200
    s_waitcnt vmcnt(28)
    ds_read_b128 a[152:155], v244 offset:6144
    ds_read_b128 a[156:159], v245 offset:6144
    v_lshl_add_u32 v144, v144, 7, v226
    ds_read_b64 a[16:17], v223 offset:3200
    v_xor_b32 v172, 64, v144
    ds_read_b64 a[18:19], v223 offset:3208
    v_xor_b32 v227, v145, v221
    ds_read_b64 a[20:21], v223 offset:3264
    s_waitcnt lgkmcnt(15)
    s_add_u32 m0, s61, 2048
    s_add_u32 s51, s67, 4096
    buffer_load_dwordx4 v3, s[24:27], s51 offen lds
    v_and_b32 v227, 7, v227
    ds_read_b64 a[22:23], v223 offset:3272
    v_lshlrev_b32 v227, 4, v227
    ds_read_b64 a[24:25], v223 offset:3328
    v_lshl_add_u32 v145, v145, 7, v227
    ds_read_b64 a[26:27], v223 offset:3336
    s_add_u32 m0, s61, 3072
    s_add_u32 s51, s67, 6144
    buffer_load_dwordx4 v3, s[24:27], s51 offen lds
    v_xor_b32 v173, 64, v145
    ds_read_b64 a[28:29], v223 offset:3392
    v_xor_b32 v226, v146, v221
    ds_read_b64 a[30:31], v223 offset:3400
    v_and_b32 v226, 7, v226
    ds_read_b64 a[32:33], v223 offset:6400
    v_lshlrev_b32 v226, 4, v226
    s_waitcnt vmcnt(28)
    ds_read_b128 a[160:163], v244 offset:8192
    ds_read_b128 a[164:167], v245 offset:8192
    ds_read_b64 a[34:35], v223 offset:6408
    v_lshl_add_u32 v146, v146, 7, v226
    ds_read_b64 a[36:37], v223 offset:6464
    v_xor_b32 v174, 64, v146
    ds_read_b64 a[38:39], v223 offset:6472
    v_xor_b32 v227, v147, v221
    s_waitcnt lgkmcnt(15)
    s_add_u32 m0, s61, 4096
    s_add_u32 s51, s67, 8192
    buffer_load_dwordx4 v3, s[24:27], s51 offen lds
    ds_read_b64 a[40:41], v223 offset:6528
    v_and_b32 v227, 7, v227
    ds_read_b64 a[42:43], v223 offset:6536
    v_lshlrev_b32 v227, 4, v227
    ds_read_b64 a[44:45], v223 offset:6592
    v_lshl_add_u32 v147, v147, 7, v227
    s_add_u32 m0, s61, 5120
    s_add_u32 s51, s67, 10240
    buffer_load_dwordx4 v3, s[24:27], s51 offen lds
    ds_read_b64 a[46:47], v223 offset:6600
    v_xor_b32 v175, 64, v147
    ds_read_b64 a[48:49], v223 offset:9600
    v_xor_b32 v226, v148, v221
    ds_read_b64 a[50:51], v223 offset:9608
    v_and_b32 v226, 7, v226
    s_waitcnt vmcnt(28)
    ds_read_b128 a[168:171], v244 offset:10240
    ds_read_b128 a[172:175], v245 offset:10240
    ds_read_b64 a[52:53], v223 offset:9664
    v_lshlrev_b32 v226, 4, v226
    ds_read_b64 a[54:55], v223 offset:9672
    v_lshl_add_u32 v148, v148, 7, v226
    ds_read_b64 a[56:57], v223 offset:9728
    v_xor_b32 v176, 64, v148
    s_waitcnt lgkmcnt(15)
    s_add_u32 m0, s61, 6144
    s_add_u32 s51, s67, 12288
    buffer_load_dwordx4 v3, s[24:27], s51 offen lds
    ds_read_b64 a[58:59], v223 offset:9736
    v_xor_b32 v227, v149, v221
    ds_read_b64 a[60:61], v223 offset:9792
    v_and_b32 v227, 7, v227
    ds_read_b64 a[62:63], v223 offset:9800
    v_lshlrev_b32 v227, 4, v227
    ds_read_b64 a[64:65], v223 offset:12800
    s_add_u32 m0, s61, 7168
    s_add_u32 s51, s67, 14336
    buffer_load_dwordx4 v3, s[24:27], s51 offen lds
    v_lshl_add_u32 v149, v149, 7, v227
    ds_read_b64 a[66:67], v223 offset:12808
    v_xor_b32 v177, 64, v149
    ds_read_b64 a[68:69], v223 offset:12864
    v_xor_b32 v226, v150, v221
    ds_read_b64 a[70:71], v223 offset:12872
    s_waitcnt vmcnt(28)
    ds_read_b128 a[176:179], v244 offset:12288
    ds_read_b128 a[180:183], v245 offset:12288
    v_and_b32 v226, 7, v226
    ds_read_b64 a[72:73], v223 offset:12928
    v_lshlrev_b32 v226, 4, v226
    ds_read_b64 a[74:75], v223 offset:12936
    v_lshl_add_u32 v150, v150, 7, v226
    ds_read_b64 a[76:77], v223 offset:12992
    s_waitcnt lgkmcnt(15)
    s_add_u32 m0, s61, 8192
    s_add_u32 s51, s67, 16384
    buffer_load_dwordx4 v3, s[24:27], s51 offen lds
    v_xor_b32 v178, 64, v150
    ds_read_b64 a[78:79], v223 offset:13000
    v_xor_b32 v227, v151, v221
    ds_read_b64 a[80:81], v223 offset:16000
    v_and_b32 v227, 7, v227
    ds_read_b64 a[82:83], v223 offset:16008
    s_add_u32 m0, s61, 9216
    s_add_u32 s51, s67, 18432
    buffer_load_dwordx4 v3, s[24:27], s51 offen lds
    v_lshlrev_b32 v227, 4, v227
    ds_read_b64 a[84:85], v223 offset:16064
    v_lshl_add_u32 v151, v151, 7, v227
    ds_read_b64 a[86:87], v223 offset:16072
    v_xor_b32 v179, 64, v151
    ds_read_b64 a[88:89], v223 offset:16128
    s_waitcnt vmcnt(28)
    ds_read_b128 a[184:187], v244 offset:14336
    ds_read_b128 a[188:191], v245 offset:14336
    v_xor_b32 v226, v152, v221
    ds_read_b64 a[90:91], v223 offset:16136
    v_and_b32 v226, 7, v226
    ds_read_b64 a[92:93], v223 offset:16192
    ds_read_b64 a[94:95], v223 offset:16200
    ds_read_b64 a[96:97], v240 offset:19200
    s_waitcnt lgkmcnt(15)
    s_add_u32 m0, s61, 10240
    s_add_u32 s51, s67, 20480
    buffer_load_dwordx4 v3, s[24:27], s51 offen lds
    ds_read_b64 a[98:99], v240 offset:19208
    ds_read_b64 a[100:101], v240 offset:19264
    ds_read_b64 a[102:103], v240 offset:19272
    ds_read_b64 a[104:105], v240 offset:19328
    ds_read_b64 a[106:107], v240 offset:19336
    ds_read_b64 a[108:109], v240 offset:19392
    ds_read_b64 a[110:111], v240 offset:19400
    s_add_u32 m0, s61, 11264
    s_add_u32 s51, s67, 22528
    buffer_load_dwordx4 v3, s[24:27], s51 offen lds
    s_waitcnt lgkmcnt(0)
    v_mfma_f32_16x16x32_bf16 v[32:35], a[0:3], v[228:231], 0
    v_lshlrev_b32 v226, 4, v226
    v_lshl_add_u32 v152, v152, 7, v226
    v_mfma_f32_16x16x32_bf16 v[36:39], a[0:3], v[232:235], 0
    v_xor_b32 v180, 64, v152
    s_waitcnt vmcnt(28)
    ds_read_b128 a[192:195], v244 offset:16384
    ds_read_b128 a[196:199], v245 offset:16384
    v_xor_b32 v227, v153, v221
    v_mfma_f32_16x16x32_bf16 v[40:43], a[4:7], v[228:231], 0
    v_and_b32 v227, 7, v227
    v_lshlrev_b32 v227, 4, v227
    v_mfma_f32_16x16x32_bf16 v[44:47], a[4:7], v[232:235], 0
    v_lshl_add_u32 v153, v153, 7, v227
    s_add_u32 m0, s61, 12288
    s_add_u32 s51, s67, 24576
    buffer_load_dwordx4 v3, s[24:27], s51 offen lds
    v_xor_b32 v181, 64, v153
    v_mfma_f32_16x16x32_bf16 v[48:51], a[8:11], v[228:231], 0
    v_xor_b32 v226, v154, v221
    v_and_b32 v226, 7, v226
    v_mfma_f32_16x16x32_bf16 v[52:55], a[8:11], v[232:235], 0
    v_lshlrev_b32 v226, 4, v226
    s_add_u32 m0, s61, 13312
    s_add_u32 s51, s67, 26624
    buffer_load_dwordx4 v3, s[24:27], s51 offen lds
    v_lshl_add_u32 v154, v154, 7, v226
    v_mfma_f32_16x16x32_bf16 v[56:59], a[96:99], v[228:231], 0
    v_xor_b32 v182, 64, v154
    v_xor_b32 v227, v155, v221
    v_mfma_f32_16x16x32_bf16 v[60:63], a[16:19], v[232:235], 0
    v_and_b32 v227, 7, v227
    s_waitcnt vmcnt(28)
    ds_read_b128 a[200:203], v244 offset:18432
    ds_read_b128 a[204:207], v245 offset:18432
    v_lshlrev_b32 v227, 4, v227
    v_mfma_f32_16x16x32_bf16 v[64:67], a[20:23], v[228:231], 0
    v_lshl_add_u32 v155, v155, 7, v227
    v_xor_b32 v183, 64, v155
    v_mfma_f32_16x16x32_bf16 v[68:71], a[20:23], v[232:235], 0
    v_xor_b32 v226, v156, v221
    s_add_u32 m0, s61, 14336
    s_add_u32 s51, s67, 28672
    buffer_load_dwordx4 v3, s[24:27], s51 offen lds
    v_and_b32 v226, 7, v226
    v_mfma_f32_16x16x32_bf16 v[72:75], a[24:27], v[228:231], 0
    v_lshlrev_b32 v226, 4, v226
    v_lshl_add_u32 v156, v156, 7, v226
    v_mfma_f32_16x16x32_bf16 v[76:79], a[24:27], v[232:235], 0
    v_xor_b32 v184, 64, v156
    v_xor_b32 v227, v157, v221
    s_add_u32 m0, s61, 15360
    s_add_u32 s51, s67, 30720
    buffer_load_dwordx4 v3, s[24:27], s51 offen lds
    v_mfma_f32_16x16x32_bf16 v[80:83], a[96:99], v[232:235], 0
    v_and_b32 v227, 7, v227
    v_lshlrev_b32 v227, 4, v227
    v_mfma_f32_16x16x32_bf16 v[84:87], a[36:39], v[228:231], 0
    v_lshl_add_u32 v157, v157, 7, v227
    v_xor_b32 v185, 64, v157
    s_waitcnt vmcnt(28)
    ds_read_b128 a[208:211], v244 offset:20480
    ds_read_b128 a[212:215], v245 offset:20480
    v_mfma_f32_16x16x32_bf16 v[88:91], a[36:39], v[232:235], 0
    v_xor_b32 v226, v158, v221
    v_and_b32 v226, 7, v226
    v_mfma_f32_16x16x32_bf16 v[92:95], a[40:43], v[228:231], 0
    v_lshlrev_b32 v226, 4, v226
    v_lshl_add_u32 v158, v158, 7, v226
    s_waitcnt lgkmcnt(4)
    s_add_u32 m0, s61, 16384
    s_add_u32 s51, s67, 32768
    buffer_load_dwordx4 v3, s[24:27], s51 offen lds
    v_mfma_f32_16x16x32_bf16 v[96:99], a[40:43], v[232:235], 0
    v_xor_b32 v186, 64, v158
    v_xor_b32 v227, v159, v221
    v_mfma_f32_16x16x32_bf16 v[100:103], a[100:103], v[228:231], 0
    v_and_b32 v227, 7, v227
    v_lshlrev_b32 v227, 4, v227
    s_add_u32 m0, s61, 17408
    s_add_u32 s51, s67, 34816
    buffer_load_dwordx4 v3, s[24:27], s51 offen lds
    v_mfma_f32_16x16x32_bf16 v[104:107], a[52:55], v[232:235], 0
    v_lshl_add_u32 v159, v159, 7, v227
    v_xor_b32 v187, 64, v159
    v_mfma_f32_16x16x32_bf16 v[108:111], a[56:59], v[228:231], 0
    v_xor_b32 v226, v160, v221
    v_and_b32 v226, 7, v226
    s_waitcnt vmcnt(28)
    ds_read_b128 a[216:219], v244 offset:22528
    ds_read_b128 a[220:223], v245 offset:22528
    v_mfma_f32_16x16x32_bf16 v[112:115], a[56:59], v[232:235], 0
    v_lshlrev_b32 v226, 4, v226
    v_lshl_add_u32 v160, v160, 7, v226
    v_mfma_f32_16x16x32_bf16 v[116:119], a[100:103], v[232:235], 0
    v_xor_b32 v188, 64, v160
    v_xor_b32 v227, v161, v221
    v_mfma_f32_16x16x32_bf16 v[120:123], a[72:75], v[228:231], 0
    s_waitcnt lgkmcnt(4)
    s_add_u32 m0, s61, 18432
    s_add_u32 s51, s67, 36864
    buffer_load_dwordx4 v3, s[24:27], s51 offen lds
    v_and_b32 v227, 7, v227
    v_lshlrev_b32 v227, 4, v227
    v_mfma_f32_16x16x32_bf16 v[124:127], a[72:75], v[232:235], 0
    v_lshl_add_u32 v161, v161, 7, v227
    v_xor_b32 v189, 64, v161
    v_mfma_f32_16x16x32_bf16 v[128:131], a[104:107], v[228:231], 0
    s_add_u32 m0, s61, 19456
    s_add_u32 s51, s67, 38912
    buffer_load_dwordx4 v3, s[24:27], s51 offen lds
    v_xor_b32 v226, v162, v221
    v_and_b32 v226, 7, v226
    v_mfma_f32_16x16x32_bf16 v[132:135], a[88:91], v[232:235], 0
    v_lshlrev_b32 v226, 4, v226
    v_lshl_add_u32 v162, v162, 7, v226
    v_mfma_f32_16x16x32_bf16 v[136:139], a[104:107], v[232:235], 0
    s_waitcnt vmcnt(28)
    ds_read_b128 a[224:227], v244 offset:24576
    ds_read_b128 a[228:231], v245 offset:24576
    v_xor_b32 v190, 64, v162
    v_xor_b32 v227, v163, v221
    v_mfma_f32_16x16x32_bf16 v[140:143], a[108:111], v[236:239], 0
    v_and_b32 v227, 7, v227
    v_lshlrev_b32 v227, 4, v227
    v_mfma_f32_16x16x32_bf16 v[36:39], v[228:231], a[16:19], v[36:39]
    s_waitcnt lgkmcnt(4)
    s_add_u32 m0, s61, 20480
    s_add_u32 s51, s67, 40960
    buffer_load_dwordx4 v3, s[24:27], s51 offen lds
    v_lshl_add_u32 v163, v163, 7, v227
    v_xor_b32 v191, 64, v163
    v_mfma_f32_16x16x32_bf16 v[40:43], v[228:231], a[32:35], v[40:43]
    v_xor_b32 v226, v164, v221
    v_and_b32 v226, 7, v226
    v_mfma_f32_16x16x32_bf16 v[44:47], v[228:231], a[48:51], v[44:47]
    s_add_u32 m0, s61, 21504
    s_add_u32 s51, s67, 43008
    buffer_load_dwordx4 v3, s[24:27], s51 offen lds
    v_lshlrev_b32 v226, 4, v226
    v_lshl_add_u32 v164, v164, 7, v226
    v_mfma_f32_16x16x32_bf16 v[48:51], v[228:231], a[64:67], v[48:51]
    v_xor_b32 v192, 64, v164
    v_xor_b32 v227, v165, v221
    v_mfma_f32_16x16x32_bf16 v[52:55], v[228:231], a[80:83], v[52:55]
    s_waitcnt vmcnt(28)
    ds_read_b128 a[232:235], v244 offset:26624
    ds_read_b128 a[236:239], v245 offset:26624
    v_and_b32 v227, 7, v227
    v_lshlrev_b32 v227, 4, v227
    v_mfma_f32_16x16x32_bf16 v[56:59], v[236:239], a[12:15], v[56:59]
    v_lshl_add_u32 v165, v165, 7, v227
    v_xor_b32 v193, 64, v165
    v_mfma_f32_16x16x32_bf16 v[64:67], v[232:235], a[32:35], v[64:67]
    v_xor_b32 v226, v166, v221
    s_waitcnt lgkmcnt(4)
    s_add_u32 m0, s61, 22528
    s_add_u32 s51, s67, 45056
    buffer_load_dwordx4 v3, s[24:27], s51 offen lds
    v_and_b32 v226, 7, v226
    v_mfma_f32_16x16x32_bf16 v[68:71], v[232:235], a[48:51], v[68:71]
    v_lshlrev_b32 v226, 4, v226
    v_lshl_add_u32 v166, v166, 7, v226
    v_mfma_f32_16x16x32_bf16 v[72:75], v[232:235], a[64:67], v[72:75]
    v_xor_b32 v194, 64, v166
    s_add_u32 m0, s61, 23552
    s_add_u32 s51, s67, 47104
    buffer_load_dwordx4 v3, s[24:27], s51 offen lds
    v_xor_b32 v227, v167, v221
    v_mfma_f32_16x16x32_bf16 v[76:79], v[232:235], a[80:83], v[76:79]
    v_and_b32 v227, 7, v227
    v_lshlrev_b32 v227, 4, v227
    v_mfma_f32_16x16x32_bf16 v[80:83], v[236:239], a[28:31], v[80:83]
    v_lshl_add_u32 v167, v167, 7, v227
    s_waitcnt vmcnt(28)
    ds_read_b128 a[240:243], v244 offset:28672
    ds_read_b128 a[244:247], v245 offset:28672
    v_xor_b32 v195, 64, v167
    v_mfma_f32_16x16x32_bf16 v[88:91], v[228:231], a[52:55], v[88:91]
    v_xor_b32 v226, v168, v221
    v_and_b32 v226, 7, v226
    v_mfma_f32_16x16x32_bf16 v[92:95], v[228:231], a[68:71], v[92:95]
    v_lshlrev_b32 v226, 4, v226
    s_waitcnt lgkmcnt(4)
    s_add_u32 m0, s61, 24576
    s_add_u32 s51, s67, 49152
    buffer_load_dwordx4 v3, s[24:27], s51 offen lds
    v_lshl_add_u32 v168, v168, 7, v226
    v_mfma_f32_16x16x32_bf16 v[96:99], v[228:231], a[84:87], v[96:99]
    v_xor_b32 v196, 64, v168
    v_xor_b32 v227, v169, v221
    v_mfma_f32_16x16x32_bf16 v[100:103], v[236:239], a[44:47], v[100:103]
    v_and_b32 v227, 7, v227
    s_add_u32 m0, s61, 25600
    s_add_u32 s51, s67, 51200
    buffer_load_dwordx4 v3, s[24:27], s51 offen lds
    v_lshlrev_b32 v227, 4, v227
    v_mfma_f32_16x16x32_bf16 v[108:111], v[232:235], a[68:71], v[108:111]
    v_lshl_add_u32 v169, v169, 7, v227
    v_xor_b32 v197, 64, v169
    v_mfma_f32_16x16x32_bf16 v[112:115], v[232:235], a[84:87], v[112:115]
    v_xor_b32 v226, v170, v221
    s_waitcnt vmcnt(28)
    ds_read_b128 a[248:251], v244 offset:30720
    ds_read_b128 a[252:255], v245 offset:30720
    v_and_b32 v226, 7, v226
    v_mfma_f32_16x16x32_bf16 v[116:119], v[236:239], a[60:63], v[116:119]
    v_lshlrev_b32 v226, 4, v226
    v_lshl_add_u32 v170, v170, 7, v226
    v_mfma_f32_16x16x32_bf16 v[124:127], v[228:231], a[88:91], v[124:127]
    v_xor_b32 v198, 64, v170
    v_xor_b32 v227, v171, v221
    s_waitcnt lgkmcnt(4)
    s_add_u32 m0, s61, 26624
    s_add_u32 s51, s67, 53248
    buffer_load_dwordx4 v3, s[24:27], s51 offen lds
    v_mfma_f32_16x16x32_bf16 v[128:131], v[236:239], a[76:79], v[128:131]
    v_and_b32 v227, 7, v227
    v_lshlrev_b32 v227, 4, v227
    v_mfma_f32_16x16x32_bf16 v[136:139], v[236:239], a[92:95], v[136:139]
    v_lshl_add_u32 v171, v171, 7, v227
    v_xor_b32 v199, 64, v171
    s_add_u32 m0, s61, 27648
    s_add_u32 s51, s67, 55296
    buffer_load_dwordx4 v3, s[24:27], s51 offen lds
    s_mov_b32 s44, s18
    s_and_b32 s45, s19, 0xffff
    s_mov_b32 s46, 8192
    s_mov_b32 s47, 0x00020000
    s_mov_b32 s62, 0x05040100
    s_mov_b32 s63, 0x07060302
    v_mov_b32 v9, 0
    v_lshrrev_b32 v226, 4, v0
    s_waitcnt lgkmcnt(2)
    s_add_u32 m0, s61, 28672
    s_add_u32 s51, s67, 57344
    buffer_load_dwordx4 v3, s[24:27], s51 offen lds
    v_lshlrev_b32 v226, 13, v226
    s_lshl_b32 s54, s49, 3
    v_add_u32 v226, s54, v226
    v_and_b32 v227, 7, v220
    v_lshl_add_u32 v8, v227, 17, v226
    v_lshrrev_b32 v227, 3, v220
    s_add_u32 m0, s61, 29696
    s_add_u32 s51, s67, 59392
    buffer_load_dwordx4 v3, s[24:27], s51 offen lds
    v_lshl_add_u32 v8, v227, 12, v8
    v_lshrrev_b32 v227, 2, v220
    v_lshl_add_u32 v248, v227, 17, v226
    v_bfe_u32 v227, v220, 1, 1
    v_lshl_add_u32 v248, v227, 2, v248
    v_and_b32 v227, 1, v220
    s_waitcnt lgkmcnt(0)
    s_add_u32 m0, s61, 30720
    s_add_u32 s51, s67, 61440
    buffer_load_dwordx4 v3, s[24:27], s51 offen lds
    v_cmp_eq_u32 vcc, 1, v227
    v_mov_b32 v246, s62
    v_mov_b32 v227, s63
    v_cndmask_b32 v246, v246, v227, vcc
    v_lshrrev_b32 v227, 2, v222
    v_xor_b32 v227, v227, v221
    s_add_u32 m0, s61, 31744
    s_add_u32 s51, s67, 63488
    buffer_load_dwordx4 v3, s[24:27], s51 offen lds
    v_lshlrev_b32 v227, 3, v227
    v_lshl_add_u32 v227, v222, 5, v227
    s_lshl_b32 s54, s48, 13
    s_add_u32 s54, s54, 65536
    v_add_u32 v13, s54, v227
    s_lshl_b32 s54, s48, 14
    v_lshlrev_b32 v1, 6, v221
    v_add_u32 v1, s54, v1
    v_lshl_add_u32 v1, v220, 2, v1
    v_lshrrev_b32 v226, 3, v220
    v_and_b32 v227, 1, v221
    v_cmp_eq_u32 vcc, v226, v227
    v_mov_b32 v227, 0x3f80
    s_nop 0
    v_cndmask_b32 v227, 0, v227, vcc
    v_and_b32 v226, 4, v220
    v_cmp_eq_u32 vcc, 0, v226
    s_nop 1
    v_cndmask_b32 v4, 0, v227, vcc
    v_cndmask_b32 v6, v227, 0, vcc
    v_mov_b32 v5, v4
    v_mov_b32 v7, v6
    s_lshl_b32 s60, s48, 11
    s_add_u32 s60, s60, 131072
    v_add_u32 v247, s60, v2
    v_and_b32 v226, 7, v220
    v_lshlrev_b32 v226, 5, v226
    v_lshl_add_u32 v226, v221, 8, v226
    v_and_b32 v227, 8, v220
    v_add3_u32 v11, v226, v227, s60
    v_add_u32 v10, 131072, v2
    s_xor_b32 s54, s2, 8
    s_mul_i32 s64, s54, 41984
    s_add_u32 s64, s64, 1048576
    s_lshl_b32 s54, s48, 7
    s_add_u32 s66, s64, s54
    s_add_u32 s66, s66, 40960
    s_lshl_b32 s54, s48, 13
    s_add_u32 s64, s64, s54
    s_mul_i32 s57, s50, 6291456
    s_add_u32 s58, s57, 6291456
    s_lshl_b32 s55, s2, 15
    s_mul_i32 s54, s48, 7168
    s_add_u32 s55, s55, s54
    s_add_u32 s55, s55, 12582912
    s_lshl_b32 s54, s50, 2
    s_add_u32 s54, s54, s48
    s_mul_i32 s54, s54, 102400
    s_add_u32 s8, s22, s54
    s_addc_u32 s9, s23, 0
    s_and_b32 s9, s9, 0xffff
    s_mov_b32 s10, 102400
    s_mov_b32 s11, 0x00020000
    s_mov_b32 s59, 0
    s_add_u32 s53, s55, 4096
    v_mov_b32 v216, 0
    v_mov_b32 v217, 0
    v_mov_b32 v218, 0
    v_mov_b32 v219, 0
    v_mov_b32 v223, 0
    v_mov_b32 v224, 0
    v_mov_b32 v225, 0
    v_mov_b32 v240, 0
    s_waitcnt lgkmcnt(0)
    s_and_b32 s71, s69, 0xffff0000
    s_lshl_b32 s70, s69, 16
    s_and_b32 s69, s68, 0xffff0000
    s_lshl_b32 s68, s68, 16
    s_and_b32 s75, s73, 0xffff0000
    s_lshl_b32 s74, s73, 16
    s_and_b32 s73, s72, 0xffff0000
    s_lshl_b32 s72, s72, 16
    s_lshl_b32 s76, s76, 16
    s_waitcnt vmcnt(0)
    s_barrier
    s_cmp_lg_u32 s48, 0
    s_cbranch_scc1 L_noarr1
    s_mov_b64 exec, 1
    s_bfe_u32 s51, s2, 0x20003
    s_lshl_b32 s51, s51, 6
    v_mov_b32 v226, s51
    v_mov_b32 v227, 1
    global_atomic_add v226, v227, s[20:21]
    s_mov_b64 exec, -1
L_noarr1:
    ds_read_b128 a[0:3], v144
    ds_read_b128 a[4:7], v172
    ds_read_b128 a[8:11], v145
    ds_read_b128 a[12:15], v173
    ds_read_b128 a[16:19], v146
    ds_read_b128 a[20:23], v174
    ds_read_b128 a[24:27], v147
    ds_read_b128 a[28:31], v175
    ds_read_b128 a[32:35], v148
    ds_read_b128 a[36:39], v176
    ds_read_b128 a[40:43], v149
    ds_read_b128 a[44:47], v177
    ds_read_b128 a[48:51], v150
    ds_read_b128 a[52:55], v178
    s_waitcnt lgkmcnt(12)
    v_mfma_f32_16x16x32_bf16 v[200:203], a[0:3], a[0:3], 0
    v_mfma_f32_16x16x32_bf16 v[200:203], a[4:7], a[4:7], v[200:203]
    buffer_load_dword v252, v249, s[28:31], s3 offen
    s_add_u32 s3, s3, 2097152
    s_waitcnt lgkmcnt(10)
    v_mfma_f32_16x16x32_bf16 v[204:207], a[0:3], a[8:11], 0
    v_mfma_f32_16x16x32_bf16 v[204:207], a[4:7], a[12:15], v[204:207]
    buffer_load_dword v251, v249, s[28:31], s3 offen
    s_add_u32 s3, s3, 2097152
    s_waitcnt lgkmcnt(8)
    v_mfma_f32_16x16x32_bf16 v[208:211], a[0:3], a[16:19], 0
    v_mfma_f32_16x16x32_bf16 v[208:211], a[4:7], a[20:23], v[208:211]
    s_waitcnt lgkmcnt(6)
    v_mfma_f32_16x16x32_bf16 v[212:215], a[0:3], a[24:27], 0
    v_fmac_f32 v216, v200, v32
    v_fmac_f32 v217, v201, v33
    v_mfma_f32_16x16x32_bf16 v[212:215], a[4:7], a[28:31], v[212:215]
    s_waitcnt lgkmcnt(4)
    v_fmac_f32 v216, v202, v34
    v_fmac_f32 v217, v203, v35
    v_mfma_f32_16x16x32_bf16 v[200:203], a[0:3], a[32:35], 0
    v_fmac_f32 v216, v204, v36
    v_fmac_f32 v217, v205, v37
    v_mfma_f32_16x16x32_bf16 v[200:203], a[4:7], a[36:39], v[200:203]
    s_waitcnt lgkmcnt(2)
    v_fmac_f32 v216, v206, v38
    v_fmac_f32 v217, v207, v39
    v_mfma_f32_16x16x32_bf16 v[204:207], a[0:3], a[40:43], 0
    v_fmac_f32 v216, v208, v40
    v_fmac_f32 v217, v209, v41
    v_mfma_f32_16x16x32_bf16 v[204:207], a[4:7], a[44:47], v[204:207]
    s_waitcnt lgkmcnt(0)
    v_fmac_f32 v216, v210, v42
    v_fmac_f32 v217, v211, v43
    v_mfma_f32_16x16x32_bf16 v[208:211], a[48:51], a[0:3], 0
    v_fmac_f32 v216, v212, v44
    v_fmac_f32 v217, v213, v45
    v_mfma_f32_16x16x32_bf16 v[208:211], a[52:55], a[4:7], v[208:211]
    v_fmac_f32 v216, v214, v46
    v_fmac_f32 v217, v215, v47
    v_mfma_f32_16x16x32_bf16 v[212:215], a[8:11], a[8:11], 0
    ds_read_b128 a[56:59], v151
    v_fmac_f32 v216, v200, v48
    v_fmac_f32 v217, v201, v49
    v_mfma_f32_16x16x32_bf16 v[212:215], a[12:15], a[12:15], v[212:215]
    v_fmac_f32 v216, v202, v50
    v_fmac_f32 v217, v203, v51
    v_mfma_f32_16x16x32_bf16 v[200:203], a[8:11], a[16:19], 0
    ds_read_b128 a[60:63], v179
    v_fmac_f32 v216, v204, v52
    v_fmac_f32 v217, v205, v53
    v_mfma_f32_16x16x32_bf16 v[200:203], a[12:15], a[20:23], v[200:203]
    v_fmac_f32 v216, v206, v54
    v_fmac_f32 v217, v207, v55
    v_mfma_f32_16x16x32_bf16 v[204:207], a[8:11], a[24:27], 0
    ds_read_b128 a[64:67], v152
    v_fmac_f32 v216, v208, v56
    v_mfma_f32_16x16x32_bf16 v[204:207], a[12:15], a[28:31], v[204:207]
    v_mfma_f32_16x16x32_bf16 v[208:211], a[8:11], a[32:35], 0
    ds_read_b128 a[68:71], v180
    v_fmac_f32 v216, v212, v60
    v_fmac_f32 v217, v213, v61
    v_mfma_f32_16x16x32_bf16 v[208:211], a[12:15], a[36:39], v[208:211]
    v_fmac_f32 v216, v214, v62
    v_fmac_f32 v217, v215, v63
    v_mfma_f32_16x16x32_bf16 v[212:215], a[8:11], a[40:43], 0
    ds_read_b128 a[72:75], v153
    v_fmac_f32 v216, v200, v64
    v_fmac_f32 v217, v201, v65
    v_mfma_f32_16x16x32_bf16 v[212:215], a[12:15], a[44:47], v[212:215]
    v_fmac_f32 v216, v202, v66
    v_fmac_f32 v217, v203, v67
    v_mfma_f32_16x16x32_bf16 v[200:203], a[48:51], a[8:11], 0
    ds_read_b128 a[76:79], v181
    v_fmac_f32 v216, v204, v68
    v_fmac_f32 v217, v205, v69
    v_mfma_f32_16x16x32_bf16 v[200:203], a[52:55], a[12:15], v[200:203]
    v_fmac_f32 v216, v206, v70
    v_fmac_f32 v217, v207, v71
    v_mfma_f32_16x16x32_bf16 v[204:207], a[16:19], a[16:19], 0
    ds_read_b128 a[80:83], v154
    v_fmac_f32 v216, v208, v72
    v_fmac_f32 v217, v209, v73
    v_mfma_f32_16x16x32_bf16 v[204:207], a[20:23], a[20:23], v[204:207]
    v_fmac_f32 v216, v210, v74
    v_fmac_f32 v217, v211, v75
    v_mfma_f32_16x16x32_bf16 v[208:211], a[16:19], a[24:27], 0
    ds_read_b128 a[84:87], v182
    v_fmac_f32 v216, v212, v76
    v_fmac_f32 v217, v213, v77
    v_mfma_f32_16x16x32_bf16 v[208:211], a[20:23], a[28:31], v[208:211]
    v_fmac_f32 v216, v214, v78
    v_fmac_f32 v217, v215, v79
    v_mfma_f32_16x16x32_bf16 v[212:215], a[16:19], a[32:35], 0
    ds_read_b128 a[88:91], v155
    v_fmac_f32 v216, v200, v80
    v_mfma_f32_16x16x32_bf16 v[212:215], a[20:23], a[36:39], v[212:215]
    v_mfma_f32_16x16x32_bf16 v[200:203], a[16:19], a[40:43], 0
    ds_read_b128 a[92:95], v183
    v_fmac_f32 v216, v204, v84
    v_fmac_f32 v217, v205, v85
    v_mfma_f32_16x16x32_bf16 v[200:203], a[20:23], a[44:47], v[200:203]
    v_fmac_f32 v216, v206, v86
    v_fmac_f32 v217, v207, v87
    v_mfma_f32_16x16x32_bf16 v[204:207], a[48:51], a[16:19], 0
    ds_read_b128 a[96:99], v156
    v_fmac_f32 v216, v208, v88
    v_fmac_f32 v217, v209, v89
    v_mfma_f32_16x16x32_bf16 v[204:207], a[52:55], a[20:23], v[204:207]
    v_fmac_f32 v216, v210, v90
    v_fmac_f32 v217, v211, v91
    v_mfma_f32_16x16x32_bf16 v[208:211], a[24:27], a[24:27], 0
    ds_read_b128 a[100:103], v184
    v_fmac_f32 v216, v212, v92
    v_fmac_f32 v217, v213, v93
    v_mfma_f32_16x16x32_bf16 v[208:211], a[28:31], a[28:31], v[208:211]
    v_fmac_f32 v216, v214, v94
    v_fmac_f32 v217, v215, v95
    v_mfma_f32_16x16x32_bf16 v[212:215], a[24:27], a[32:35], 0
    ds_read_b128 a[104:107], v157
    v_fmac_f32 v216, v200, v96
    v_fmac_f32 v217, v201, v97
    v_mfma_f32_16x16x32_bf16 v[212:215], a[28:31], a[36:39], v[212:215]
    v_fmac_f32 v216, v202, v98
    v_fmac_f32 v217, v203, v99
    v_mfma_f32_16x16x32_bf16 v[200:203], a[24:27], a[40:43], 0
    ds_read_b128 a[108:111], v185
    v_fmac_f32 v216, v204, v100
    v_mfma_f32_16x16x32_bf16 v[200:203], a[28:31], a[44:47], v[200:203]
    v_mfma_f32_16x16x32_bf16 v[204:207], a[48:51], a[24:27], 0
    v_fmac_f32 v216, v208, v104
    v_fmac_f32 v217, v209, v105
    v_mfma_f32_16x16x32_bf16 v[204:207], a[52:55], a[28:31], v[204:207]
    v_fmac_f32 v216, v210, v106
    v_fmac_f32 v217, v211, v107
    v_mfma_f32_16x16x32_bf16 v[208:211], a[32:35], a[32:35], 0
    v_fmac_f32 v216, v212, v108
    v_fmac_f32 v217, v213, v109
    v_mfma_f32_16x16x32_bf16 v[208:211], a[36:39], a[36:39], v[208:211]
    v_fmac_f32 v216, v214, v110
    v_fmac_f32 v217, v215, v111
    v_mfma_f32_16x16x32_bf16 v[212:215], a[32:35], a[40:43], 0
    v_fmac_f32 v216, v200, v112
    v_fmac_f32 v217, v201, v113
    v_mfma_f32_16x16x32_bf16 v[212:215], a[36:39], a[44:47], v[212:215]
    v_fmac_f32 v216, v202, v114
    v_fmac_f32 v217, v203, v115
    v_mfma_f32_16x16x32_bf16 v[200:203], a[48:51], a[32:35], 0
    v_fmac_f32 v216, v204, v116
    v_mfma_f32_16x16x32_bf16 v[200:203], a[52:55], a[36:39], v[200:203]
    v_mfma_f32_16x16x32_bf16 v[204:207], a[40:43], a[40:43], 0
    v_fmac_f32 v216, v208, v120
    v_fmac_f32 v217, v209, v121
    v_mfma_f32_16x16x32_bf16 v[204:207], a[44:47], a[44:47], v[204:207]
    v_fmac_f32 v216, v210, v122
    v_fmac_f32 v217, v211, v123
    v_mfma_f32_16x16x32_bf16 v[208:211], a[48:51], a[40:43], 0
    v_fmac_f32 v216, v212, v124
    v_fmac_f32 v217, v213, v125
    v_mfma_f32_16x16x32_bf16 v[208:211], a[52:55], a[44:47], v[208:211]
    v_fmac_f32 v216, v214, v126
    v_fmac_f32 v217, v215, v127
    v_mfma_f32_16x16x32_bf16 v[212:215], a[48:51], a[48:51], 0
    v_fmac_f32 v216, v200, v128
    v_mfma_f32_16x16x32_bf16 v[212:215], a[52:55], a[52:55], v[212:215]
    s_waitcnt lgkmcnt(12)
    v_mfma_f32_16x16x32_bf16 v[200:203], a[56:59], a[56:59], 0
    v_fmac_f32 v216, v204, v132
    v_fmac_f32 v217, v205, v133
    v_mfma_f32_16x16x32_bf16 v[200:203], a[60:63], a[60:63], v[200:203]
    s_waitcnt lgkmcnt(10)
    v_fmac_f32 v216, v206, v134
    v_fmac_f32 v217, v207, v135
    v_mfma_f32_16x16x32_bf16 v[204:207], a[56:59], a[64:67], 0
    v_fmac_f32 v216, v208, v136
    v_mfma_f32_16x16x32_bf16 v[204:207], a[60:63], a[68:71], v[204:207]
    s_waitcnt lgkmcnt(8)
    v_mfma_f32_16x16x32_bf16 v[208:211], a[56:59], a[72:75], 0
    v_fmac_f32 v216, v212, v140
    v_mfma_f32_16x16x32_bf16 v[208:211], a[60:63], a[76:79], v[208:211]
    s_waitcnt lgkmcnt(6)
    v_mfma_f32_16x16x32_bf16 v[212:215], a[56:59], a[80:83], 0
    v_fmac_f32 v218, v200, v32
    v_fmac_f32 v219, v201, v33
    v_mfma_f32_16x16x32_bf16 v[212:215], a[60:63], a[84:87], v[212:215]
    s_waitcnt lgkmcnt(4)
    v_fmac_f32 v218, v202, v34
    v_fmac_f32 v219, v203, v35
    v_mfma_f32_16x16x32_bf16 v[200:203], a[56:59], a[88:91], 0
    v_fmac_f32 v218, v204, v36
    v_fmac_f32 v219, v205, v37
    v_mfma_f32_16x16x32_bf16 v[200:203], a[60:63], a[92:95], v[200:203]
    s_waitcnt lgkmcnt(2)
    v_fmac_f32 v218, v206, v38
    v_fmac_f32 v219, v207, v39
    v_mfma_f32_16x16x32_bf16 v[204:207], a[56:59], a[96:99], 0
    v_fmac_f32 v218, v208, v40
    v_fmac_f32 v219, v209, v41
    v_mfma_f32_16x16x32_bf16 v[204:207], a[60:63], a[100:103], v[204:207]
    s_waitcnt lgkmcnt(0)
    v_fmac_f32 v218, v210, v42
    v_fmac_f32 v219, v211, v43
    v_mfma_f32_16x16x32_bf16 v[208:211], a[104:107], a[56:59], 0
    v_fmac_f32 v218, v212, v44
    v_fmac_f32 v219, v213, v45
    v_mfma_f32_16x16x32_bf16 v[208:211], a[108:111], a[60:63], v[208:211]
    v_fmac_f32 v218, v214, v46
    v_fmac_f32 v219, v215, v47
    v_mfma_f32_16x16x32_bf16 v[212:215], a[64:67], a[64:67], 0
    ds_read_b128 a[0:3], v158
    v_fmac_f32 v218, v200, v48
    v_fmac_f32 v219, v201, v49
    v_mfma_f32_16x16x32_bf16 v[212:215], a[68:71], a[68:71], v[212:215]
    v_fmac_f32 v218, v202, v50
    v_fmac_f32 v219, v203, v51
    v_mfma_f32_16x16x32_bf16 v[200:203], a[64:67], a[72:75], 0
    ds_read_b128 a[4:7], v186
    v_fmac_f32 v218, v204, v52
    v_fmac_f32 v219, v205, v53
    v_mfma_f32_16x16x32_bf16 v[200:203], a[68:71], a[76:79], v[200:203]
    v_fmac_f32 v218, v206, v54
    v_fmac_f32 v219, v207, v55
    v_mfma_f32_16x16x32_bf16 v[204:207], a[64:67], a[80:83], 0
    ds_read_b128 a[8:11], v159
    v_fmac_f32 v218, v208, v56
    v_mfma_f32_16x16x32_bf16 v[204:207], a[68:71], a[84:87], v[204:207]
    v_mfma_f32_16x16x32_bf16 v[208:211], a[64:67], a[88:91], 0
    ds_read_b128 a[12:15], v187
    v_fmac_f32 v218, v212, v60
    v_fmac_f32 v219, v213, v61
    v_mfma_f32_16x16x32_bf16 v[208:211], a[68:71], a[92:95], v[208:211]
    v_fmac_f32 v218, v214, v62
    v_fmac_f32 v219, v215, v63
    v_mfma_f32_16x16x32_bf16 v[212:215], a[64:67], a[96:99], 0
    ds_read_b128 a[16:19], v160
    v_fmac_f32 v218, v200, v64
    v_fmac_f32 v219, v201, v65
    v_mfma_f32_16x16x32_bf16 v[212:215], a[68:71], a[100:103], v[212:215]
    v_fmac_f32 v218, v202, v66
    v_fmac_f32 v219, v203, v67
    v_mfma_f32_16x16x32_bf16 v[200:203], a[104:107], a[64:67], 0
    ds_read_b128 a[20:23], v188
    v_fmac_f32 v218, v204, v68
    v_fmac_f32 v219, v205, v69
    v_mfma_f32_16x16x32_bf16 v[200:203], a[108:111], a[68:71], v[200:203]
    v_fmac_f32 v218, v206, v70
    v_fmac_f32 v219, v207, v71
    v_mfma_f32_16x16x32_bf16 v[204:207], a[72:75], a[72:75], 0
    ds_read_b128 a[24:27], v161
    v_fmac_f32 v218, v208, v72
    v_fmac_f32 v219, v209, v73
    v_mfma_f32_16x16x32_bf16 v[204:207], a[76:79], a[76:79], v[204:207]
    v_fmac_f32 v218, v210, v74
    v_fmac_f32 v219, v211, v75
    v_mfma_f32_16x16x32_bf16 v[208:211], a[72:75], a[80:83], 0
    ds_read_b128 a[28:31], v189
    v_fmac_f32 v218, v212, v76
    v_fmac_f32 v219, v213, v77
    v_mfma_f32_16x16x32_bf16 v[208:211], a[76:79], a[84:87], v[208:211]
    v_fmac_f32 v218, v214, v78
    v_fmac_f32 v219, v215, v79
    v_mfma_f32_16x16x32_bf16 v[212:215], a[72:75], a[88:91], 0
    ds_read_b128 a[32:35], v162
    v_fmac_f32 v218, v200, v80
    v_mfma_f32_16x16x32_bf16 v[212:215], a[76:79], a[92:95], v[212:215]
    v_mfma_f32_16x16x32_bf16 v[200:203], a[72:75], a[96:99], 0
    ds_read_b128 a[36:39], v190
    v_fmac_f32 v218, v204, v84
    v_fmac_f32 v219, v205, v85
    v_mfma_f32_16x16x32_bf16 v[200:203], a[76:79], a[100:103], v[200:203]
    v_fmac_f32 v218, v206, v86
    v_fmac_f32 v219, v207, v87
    v_mfma_f32_16x16x32_bf16 v[204:207], a[104:107], a[72:75], 0
    ds_read_b128 a[40:43], v163
    v_fmac_f32 v218, v208, v88
    v_fmac_f32 v219, v209, v89
    v_mfma_f32_16x16x32_bf16 v[204:207], a[108:111], a[76:79], v[204:207]
    v_fmac_f32 v218, v210, v90
    v_fmac_f32 v219, v211, v91
    v_mfma_f32_16x16x32_bf16 v[208:211], a[80:83], a[80:83], 0
    ds_read_b128 a[44:47], v191
    v_fmac_f32 v218, v212, v92
    v_fmac_f32 v219, v213, v93
    v_mfma_f32_16x16x32_bf16 v[208:211], a[84:87], a[84:87], v[208:211]
    v_fmac_f32 v218, v214, v94
    v_fmac_f32 v219, v215, v95
    v_mfma_f32_16x16x32_bf16 v[212:215], a[80:83], a[88:91], 0
    ds_read_b128 a[48:51], v164
    v_fmac_f32 v218, v200, v96
    v_fmac_f32 v219, v201, v97
    v_mfma_f32_16x16x32_bf16 v[212:215], a[84:87], a[92:95], v[212:215]
    v_fmac_f32 v218, v202, v98
    v_fmac_f32 v219, v203, v99
    v_mfma_f32_16x16x32_bf16 v[200:203], a[80:83], a[96:99], 0
    ds_read_b128 a[52:55], v192
    v_fmac_f32 v218, v204, v100
    v_mfma_f32_16x16x32_bf16 v[200:203], a[84:87], a[100:103], v[200:203]
    v_mfma_f32_16x16x32_bf16 v[204:207], a[104:107], a[80:83], 0
    v_fmac_f32 v218, v208, v104
    v_fmac_f32 v219, v209, v105
    v_mfma_f32_16x16x32_bf16 v[204:207], a[108:111], a[84:87], v[204:207]
    v_fmac_f32 v218, v210, v106
    v_fmac_f32 v219, v211, v107
    v_mfma_f32_16x16x32_bf16 v[208:211], a[88:91], a[88:91], 0
    v_fmac_f32 v218, v212, v108
    v_fmac_f32 v219, v213, v109
    v_mfma_f32_16x16x32_bf16 v[208:211], a[92:95], a[92:95], v[208:211]
    v_fmac_f32 v218, v214, v110
    v_fmac_f32 v219, v215, v111
    v_mfma_f32_16x16x32_bf16 v[212:215], a[88:91], a[96:99], 0
    v_fmac_f32 v218, v200, v112
    v_fmac_f32 v219, v201, v113
    v_mfma_f32_16x16x32_bf16 v[212:215], a[92:95], a[100:103], v[212:215]
    v_fmac_f32 v218, v202, v114
    v_fmac_f32 v219, v203, v115
    v_mfma_f32_16x16x32_bf16 v[200:203], a[104:107], a[88:91], 0
    v_fmac_f32 v218, v204, v116
    v_mfma_f32_16x16x32_bf16 v[200:203], a[108:111], a[92:95], v[200:203]
    v_mfma_f32_16x16x32_bf16 v[204:207], a[96:99], a[96:99], 0
    v_fmac_f32 v218, v208, v120
    v_fmac_f32 v219, v209, v121
    v_mfma_f32_16x16x32_bf16 v[204:207], a[100:103], a[100:103], v[204:207]
    v_fmac_f32 v218, v210, v122
    v_fmac_f32 v219, v211, v123
    v_mfma_f32_16x16x32_bf16 v[208:211], a[104:107], a[96:99], 0
    v_fmac_f32 v218, v212, v124
    v_fmac_f32 v219, v213, v125
    v_mfma_f32_16x16x32_bf16 v[208:211], a[108:111], a[100:103], v[208:211]
    v_fmac_f32 v218, v214, v126
    v_fmac_f32 v219, v215, v127
    v_mfma_f32_16x16x32_bf16 v[212:215], a[104:107], a[104:107], 0
    v_fmac_f32 v218, v200, v128
    v_mfma_f32_16x16x32_bf16 v[212:215], a[108:111], a[108:111], v[212:215]
    s_waitcnt lgkmcnt(12)
    v_mfma_f32_16x16x32_bf16 v[200:203], a[0:3], a[0:3], 0
    v_fmac_f32 v218, v204, v132
    v_fmac_f32 v219, v205, v133
    v_mfma_f32_16x16x32_bf16 v[200:203], a[4:7], a[4:7], v[200:203]
    s_waitcnt lgkmcnt(10)
    v_fmac_f32 v218, v206, v134
    v_fmac_f32 v219, v207, v135
    v_mfma_f32_16x16x32_bf16 v[204:207], a[0:3], a[8:11], 0
    v_fmac_f32 v218, v208, v136
    v_mfma_f32_16x16x32_bf16 v[204:207], a[4:7], a[12:15], v[204:207]
    s_waitcnt lgkmcnt(8)
    v_mfma_f32_16x16x32_bf16 v[208:211], a[0:3], a[16:19], 0
    v_fmac_f32 v218, v212, v140
    v_mfma_f32_16x16x32_bf16 v[208:211], a[4:7], a[20:23], v[208:211]
    s_waitcnt lgkmcnt(6)
    v_mfma_f32_16x16x32_bf16 v[212:215], a[0:3], a[24:27], 0
    v_fmac_f32 v223, v200, v32
    v_fmac_f32 v224, v201, v33
    v_mfma_f32_16x16x32_bf16 v[212:215], a[4:7], a[28:31], v[212:215]
    s_waitcnt lgkmcnt(4)
    v_fmac_f32 v223, v202, v34
    v_fmac_f32 v224, v203, v35
    v_mfma_f32_16x16x32_bf16 v[200:203], a[0:3], a[32:35], 0
    v_fmac_f32 v223, v204, v36
    v_fmac_f32 v224, v205, v37
    v_mfma_f32_16x16x32_bf16 v[200:203], a[4:7], a[36:39], v[200:203]
    s_waitcnt lgkmcnt(2)
    v_fmac_f32 v223, v206, v38
    v_fmac_f32 v224, v207, v39
    v_mfma_f32_16x16x32_bf16 v[204:207], a[0:3], a[40:43], 0
    v_fmac_f32 v223, v208, v40
    v_fmac_f32 v224, v209, v41
    v_mfma_f32_16x16x32_bf16 v[204:207], a[4:7], a[44:47], v[204:207]
    s_waitcnt lgkmcnt(0)
    v_fmac_f32 v223, v210, v42
    v_fmac_f32 v224, v211, v43
    v_mfma_f32_16x16x32_bf16 v[208:211], a[48:51], a[0:3], 0
    v_fmac_f32 v223, v212, v44
    v_fmac_f32 v224, v213, v45
    v_mfma_f32_16x16x32_bf16 v[208:211], a[52:55], a[4:7], v[208:211]
    v_fmac_f32 v223, v214, v46
    v_fmac_f32 v224, v215, v47
    v_mfma_f32_16x16x32_bf16 v[212:215], a[8:11], a[8:11], 0
    ds_read_b128 a[56:59], v165
    v_fmac_f32 v223, v200, v48
    v_fmac_f32 v224, v201, v49
    v_mfma_f32_16x16x32_bf16 v[212:215], a[12:15], a[12:15], v[212:215]
    v_fmac_f32 v223, v202, v50
    v_fmac_f32 v224, v203, v51
    v_mfma_f32_16x16x32_bf16 v[200:203], a[8:11], a[16:19], 0
    ds_read_b128 a[60:63], v193
    v_fmac_f32 v223, v204, v52
    v_fmac_f32 v224, v205, v53
    v_mfma_f32_16x16x32_bf16 v[200:203], a[12:15], a[20:23], v[200:203]
    v_fmac_f32 v223, v206, v54
    v_fmac_f32 v224, v207, v55
    v_mfma_f32_16x16x32_bf16 v[204:207], a[8:11], a[24:27], 0
    ds_read_b128 a[64:67], v166
    v_fmac_f32 v223, v208, v56
    v_mfma_f32_16x16x32_bf16 v[204:207], a[12:15], a[28:31], v[204:207]
    v_mfma_f32_16x16x32_bf16 v[208:211], a[8:11], a[32:35], 0
    ds_read_b128 a[68:71], v194
    v_fmac_f32 v223, v212, v60
    v_fmac_f32 v224, v213, v61
    v_mfma_f32_16x16x32_bf16 v[208:211], a[12:15], a[36:39], v[208:211]
    s_mov_b32 s52, 12582912
    buffer_load_dword v228, v248, s[28:31], s52 offen offset:0
    v_fmac_f32 v223, v214, v62
    v_fmac_f32 v224, v215, v63
    v_mfma_f32_16x16x32_bf16 v[212:215], a[8:11], a[40:43], 0
    ds_read_b128 a[72:75], v167
    v_fmac_f32 v223, v200, v64
    v_fmac_f32 v224, v201, v65
    v_mfma_f32_16x16x32_bf16 v[212:215], a[12:15], a[44:47], v[212:215]
    v_fmac_f32 v223, v202, v66
    v_fmac_f32 v224, v203, v67
    v_mfma_f32_16x16x32_bf16 v[200:203], a[48:51], a[8:11], 0
    ds_read_b128 a[76:79], v195
    v_fmac_f32 v223, v204, v68
    v_fmac_f32 v224, v205, v69
    v_mfma_f32_16x16x32_bf16 v[200:203], a[52:55], a[12:15], v[200:203]
    buffer_load_dword v229, v248, s[28:31], s52 offen offset:1024
    v_fmac_f32 v223, v206, v70
    v_fmac_f32 v224, v207, v71
    v_mfma_f32_16x16x32_bf16 v[204:207], a[16:19], a[16:19], 0
    ds_read_b128 a[80:83], v168
    v_fmac_f32 v223, v208, v72
    v_fmac_f32 v224, v209, v73
    v_mfma_f32_16x16x32_bf16 v[204:207], a[20:23], a[20:23], v[204:207]
    v_fmac_f32 v223, v210, v74
    v_fmac_f32 v224, v211, v75
    v_mfma_f32_16x16x32_bf16 v[208:211], a[16:19], a[24:27], 0
    ds_read_b128 a[84:87], v196
    v_fmac_f32 v223, v212, v76
    v_fmac_f32 v224, v213, v77
    v_mfma_f32_16x16x32_bf16 v[208:211], a[20:23], a[28:31], v[208:211]
    buffer_load_dword v230, v248, s[28:31], s52 offen offset:2048
    v_fmac_f32 v223, v214, v78
    v_fmac_f32 v224, v215, v79
    v_mfma_f32_16x16x32_bf16 v[212:215], a[16:19], a[32:35], 0
    ds_read_b128 a[88:91], v169
    v_fmac_f32 v223, v200, v80
    v_mfma_f32_16x16x32_bf16 v[212:215], a[20:23], a[36:39], v[212:215]
    v_mfma_f32_16x16x32_bf16 v[200:203], a[16:19], a[40:43], 0
    ds_read_b128 a[92:95], v197
    v_fmac_f32 v223, v204, v84
    v_fmac_f32 v224, v205, v85
    v_mfma_f32_16x16x32_bf16 v[200:203], a[20:23], a[44:47], v[200:203]
    buffer_load_dword v231, v248, s[28:31], s52 offen offset:3072
    v_fmac_f32 v223, v206, v86
    v_fmac_f32 v224, v207, v87
    v_mfma_f32_16x16x32_bf16 v[204:207], a[48:51], a[16:19], 0
    ds_read_b128 a[96:99], v170
    v_fmac_f32 v223, v208, v88
    v_fmac_f32 v224, v209, v89
    v_mfma_f32_16x16x32_bf16 v[204:207], a[52:55], a[20:23], v[204:207]
    v_fmac_f32 v223, v210, v90
    v_fmac_f32 v224, v211, v91
    v_mfma_f32_16x16x32_bf16 v[208:211], a[24:27], a[24:27], 0
    ds_read_b128 a[100:103], v198
    v_fmac_f32 v223, v212, v92
    v_fmac_f32 v224, v213, v93
    v_mfma_f32_16x16x32_bf16 v[208:211], a[28:31], a[28:31], v[208:211]
    s_mov_b32 s52, 12587008
    buffer_load_dword v232, v248, s[28:31], s52 offen offset:0
    v_fmac_f32 v223, v214, v94
    v_fmac_f32 v224, v215, v95
    v_mfma_f32_16x16x32_bf16 v[212:215], a[24:27], a[32:35], 0
    ds_read_b128 a[104:107], v171
    v_fmac_f32 v223, v200, v96
    v_fmac_f32 v224, v201, v97
    v_mfma_f32_16x16x32_bf16 v[212:215], a[28:31], a[36:39], v[212:215]
    v_fmac_f32 v223, v202, v98
    v_fmac_f32 v224, v203, v99
    v_mfma_f32_16x16x32_bf16 v[200:203], a[24:27], a[40:43], 0
    ds_read_b128 a[108:111], v199
    v_fmac_f32 v223, v204, v100
    v_mfma_f32_16x16x32_bf16 v[200:203], a[28:31], a[44:47], v[200:203]
    buffer_load_dword v233, v248, s[28:31], s52 offen offset:1024
    v_mfma_f32_16x16x32_bf16 v[204:207], a[48:51], a[24:27], 0
    v_fmac_f32 v223, v208, v104
    v_fmac_f32 v224, v209, v105
    v_mfma_f32_16x16x32_bf16 v[204:207], a[52:55], a[28:31], v[204:207]
    v_fmac_f32 v223, v210, v106
    v_fmac_f32 v224, v211, v107
    v_mfma_f32_16x16x32_bf16 v[208:211], a[32:35], a[32:35], 0
    v_fmac_f32 v223, v212, v108
    v_fmac_f32 v224, v213, v109
    v_mfma_f32_16x16x32_bf16 v[208:211], a[36:39], a[36:39], v[208:211]
    buffer_load_dword v234, v248, s[28:31], s52 offen offset:2048
    v_fmac_f32 v223, v214, v110
    v_fmac_f32 v224, v215, v111
    v_mfma_f32_16x16x32_bf16 v[212:215], a[32:35], a[40:43], 0
    v_fmac_f32 v223, v200, v112
    v_fmac_f32 v224, v201, v113
    v_mfma_f32_16x16x32_bf16 v[212:215], a[36:39], a[44:47], v[212:215]
    v_fmac_f32 v223, v202, v114
    v_fmac_f32 v224, v203, v115
    v_mfma_f32_16x16x32_bf16 v[200:203], a[48:51], a[32:35], 0
    v_fmac_f32 v223, v204, v116
    v_mfma_f32_16x16x32_bf16 v[200:203], a[52:55], a[36:39], v[200:203]
    buffer_load_dword v235, v248, s[28:31], s52 offen offset:3072
    v_mfma_f32_16x16x32_bf16 v[204:207], a[40:43], a[40:43], 0
    v_fmac_f32 v223, v208, v120
    v_fmac_f32 v224, v209, v121
    v_mfma_f32_16x16x32_bf16 v[204:207], a[44:47], a[44:47], v[204:207]
    v_fmac_f32 v223, v210, v122
    v_fmac_f32 v224, v211, v123
    v_mfma_f32_16x16x32_bf16 v[208:211], a[48:51], a[40:43], 0
    v_fmac_f32 v223, v212, v124
    v_fmac_f32 v224, v213, v125
    v_mfma_f32_16x16x32_bf16 v[208:211], a[52:55], a[44:47], v[208:211]
    v_fmac_f32 v223, v214, v126
    v_fmac_f32 v224, v215, v127
    v_mfma_f32_16x16x32_bf16 v[212:215], a[48:51], a[48:51], 0
    v_fmac_f32 v223, v200, v128
    v_mfma_f32_16x16x32_bf16 v[212:215], a[52:55], a[52:55], v[212:215]
    v_and_b32 v226, 3, v0
    v_lshlrev_b32 v226, 6, v226
    global_load_dword v12, v226, s[20:21] sc1
    s_waitcnt lgkmcnt(12)
    v_mfma_f32_16x16x32_bf16 v[200:203], a[56:59], a[56:59], 0
    v_fmac_f32 v223, v204, v132
    v_fmac_f32 v224, v205, v133
    v_mfma_f32_16x16x32_bf16 v[200:203], a[60:63], a[60:63], v[200:203]
    s_waitcnt lgkmcnt(10)
    v_fmac_f32 v223, v206, v134
    v_fmac_f32 v224, v207, v135
    v_mfma_f32_16x16x32_bf16 v[204:207], a[56:59], a[64:67], 0
    v_fmac_f32 v223, v208, v136
    v_mfma_f32_16x16x32_bf16 v[204:207], a[60:63], a[68:71], v[204:207]
    s_waitcnt lgkmcnt(8)
    v_mfma_f32_16x16x32_bf16 v[208:211], a[56:59], a[72:75], 0
    v_fmac_f32 v223, v212, v140
    v_mfma_f32_16x16x32_bf16 v[208:211], a[60:63], a[76:79], v[208:211]
    buffer_load_dwordx2 v[24:25], v8, s[28:31], s57 offen offset:0
    s_waitcnt lgkmcnt(6)
    v_mfma_f32_16x16x32_bf16 v[212:215], a[56:59], a[80:83], 0
    v_fmac_f32 v225, v200, v32
    v_fmac_f32 v240, v201, v33
    v_mfma_f32_16x16x32_bf16 v[212:215], a[60:63], a[84:87], v[212:215]
    s_waitcnt lgkmcnt(4)
    v_fmac_f32 v225, v202, v34
    v_fmac_f32 v240, v203, v35
    v_mfma_f32_16x16x32_bf16 v[200:203], a[56:59], a[88:91], 0
    v_fmac_f32 v225, v204, v36
    v_fmac_f32 v240, v205, v37
    v_mfma_f32_16x16x32_bf16 v[200:203], a[60:63], a[92:95], v[200:203]
    ds_read_b128 a[0:3], v244 offset:0
    s_waitcnt lgkmcnt(3)
    v_fmac_f32 v225, v206, v38
    v_fmac_f32 v240, v207, v39
    v_mfma_f32_16x16x32_bf16 v[204:207], a[56:59], a[96:99], 0
    v_fmac_f32 v225, v208, v40
    v_fmac_f32 v240, v209, v41
    v_mfma_f32_16x16x32_bf16 v[204:207], a[60:63], a[100:103], v[204:207]
    ds_read_b128 a[4:7], v245 offset:0
    s_waitcnt lgkmcnt(2)
    v_fmac_f32 v225, v210, v42
    v_fmac_f32 v240, v211, v43
    v_mfma_f32_16x16x32_bf16 v[208:211], a[104:107], a[56:59], 0
    v_fmac_f32 v225, v212, v44
    v_fmac_f32 v240, v213, v45
    v_mfma_f32_16x16x32_bf16 v[208:211], a[108:111], a[60:63], v[208:211]
    ds_read_b128 a[8:11], v244 offset:2048
    v_fmac_f32 v225, v214, v46
    v_fmac_f32 v240, v215, v47
    v_mfma_f32_16x16x32_bf16 v[212:215], a[64:67], a[64:67], 0
    v_fmac_f32 v225, v200, v48
    v_fmac_f32 v240, v201, v49
    v_mfma_f32_16x16x32_bf16 v[212:215], a[68:71], a[68:71], v[212:215]
    ds_read_b128 a[12:15], v245 offset:2048
    v_fmac_f32 v225, v202, v50
    v_fmac_f32 v240, v203, v51
    v_mfma_f32_16x16x32_bf16 v[200:203], a[64:67], a[72:75], 0
    v_fmac_f32 v225, v204, v52
    v_fmac_f32 v240, v205, v53
    v_mfma_f32_16x16x32_bf16 v[200:203], a[68:71], a[76:79], v[200:203]
    ds_read_b128 a[16:19], v244 offset:4096
    v_fmac_f32 v225, v206, v54
    v_fmac_f32 v240, v207, v55
    v_mfma_f32_16x16x32_bf16 v[204:207], a[64:67], a[80:83], 0
    v_fmac_f32 v225, v208, v56
    v_mfma_f32_16x16x32_bf16 v[204:207], a[68:71], a[84:87], v[204:207]
    ds_read_b128 a[20:23], v245 offset:4096
    v_mfma_f32_16x16x32_bf16 v[208:211], a[64:67], a[88:91], 0
    v_fmac_f32 v225, v212, v60
    v_fmac_f32 v240, v213, v61
    v_mfma_f32_16x16x32_bf16 v[208:211], a[68:71], a[92:95], v[208:211]
    ds_read_b128 a[24:27], v244 offset:6144
    v_fmac_f32 v225, v214, v62
    v_fmac_f32 v240, v215, v63
    v_mfma_f32_16x16x32_bf16 v[212:215], a[64:67], a[96:99], 0
    v_fmac_f32 v225, v200, v64
    v_fmac_f32 v240, v201, v65
    v_mfma_f32_16x16x32_bf16 v[212:215], a[68:71], a[100:103], v[212:215]
    ds_read_b128 a[28:31], v245 offset:6144
    v_fmac_f32 v225, v202, v66
    v_fmac_f32 v240, v203, v67
    v_mfma_f32_16x16x32_bf16 v[200:203], a[104:107], a[64:67], 0
    v_fmac_f32 v225, v204, v68
    v_fmac_f32 v240, v205, v69
    v_mfma_f32_16x16x32_bf16 v[200:203], a[108:111], a[68:71], v[200:203]
    ds_read_b128 a[32:35], v244 offset:8192
    v_fmac_f32 v225, v206, v70
    v_fmac_f32 v240, v207, v71
    v_mfma_f32_16x16x32_bf16 v[204:207], a[72:75], a[72:75], 0
    v_fmac_f32 v225, v208, v72
    v_fmac_f32 v240, v209, v73
    v_mfma_f32_16x16x32_bf16 v[204:207], a[76:79], a[76:79], v[204:207]
    buffer_load_dwordx2 v[26:27], v8, s[28:31], s57 offen offset:1024
    ds_read_b128 a[36:39], v245 offset:8192
    v_fmac_f32 v225, v210, v74
    v_fmac_f32 v240, v211, v75
    v_mfma_f32_16x16x32_bf16 v[208:211], a[72:75], a[80:83], 0
    v_fmac_f32 v225, v212, v76
    v_fmac_f32 v240, v213, v77
    v_mfma_f32_16x16x32_bf16 v[208:211], a[76:79], a[84:87], v[208:211]
    ds_read_b128 a[40:43], v244 offset:10240
    v_fmac_f32 v225, v214, v78
    v_fmac_f32 v240, v215, v79
    v_mfma_f32_16x16x32_bf16 v[212:215], a[72:75], a[88:91], 0
    v_fmac_f32 v225, v200, v80
    v_mfma_f32_16x16x32_bf16 v[212:215], a[76:79], a[92:95], v[212:215]
    ds_read_b128 a[44:47], v245 offset:10240
    v_mfma_f32_16x16x32_bf16 v[200:203], a[72:75], a[96:99], 0
    v_fmac_f32 v225, v204, v84
    v_fmac_f32 v240, v205, v85
    v_mfma_f32_16x16x32_bf16 v[200:203], a[76:79], a[100:103], v[200:203]
    ds_read_b128 a[48:51], v244 offset:12288
    v_fmac_f32 v225, v206, v86
    v_fmac_f32 v240, v207, v87
    v_mfma_f32_16x16x32_bf16 v[204:207], a[104:107], a[72:75], 0
    v_fmac_f32 v225, v208, v88
    v_fmac_f32 v240, v209, v89
    v_mfma_f32_16x16x32_bf16 v[204:207], a[108:111], a[76:79], v[204:207]
    ds_read_b128 a[52:55], v245 offset:12288
    v_fmac_f32 v225, v210, v90
    v_fmac_f32 v240, v211, v91
    v_mfma_f32_16x16x32_bf16 v[208:211], a[80:83], a[80:83], 0
    v_fmac_f32 v225, v212, v92
    v_fmac_f32 v240, v213, v93
    v_mfma_f32_16x16x32_bf16 v[208:211], a[84:87], a[84:87], v[208:211]
    ds_read_b128 a[112:115], v244 offset:28672
    v_fmac_f32 v225, v214, v94
    v_fmac_f32 v240, v215, v95
    v_mfma_f32_16x16x32_bf16 v[212:215], a[80:83], a[88:91], 0
    v_fmac_f32 v225, v200, v96
    v_fmac_f32 v240, v201, v97
    v_mfma_f32_16x16x32_bf16 v[212:215], a[84:87], a[92:95], v[212:215]
    ds_read_b128 a[116:119], v245 offset:28672
    v_fmac_f32 v225, v202, v98
    v_fmac_f32 v240, v203, v99
    v_mfma_f32_16x16x32_bf16 v[200:203], a[80:83], a[96:99], 0
    v_fmac_f32 v225, v204, v100
    v_mfma_f32_16x16x32_bf16 v[200:203], a[84:87], a[100:103], v[200:203]
    ds_read_b128 a[120:123], v244 offset:30720
    v_mfma_f32_16x16x32_bf16 v[204:207], a[104:107], a[80:83], 0
    v_fmac_f32 v225, v208, v104
    v_fmac_f32 v240, v209, v105
    v_mfma_f32_16x16x32_bf16 v[204:207], a[108:111], a[84:87], v[204:207]
    ds_read_b128 a[124:127], v245 offset:30720
    v_fmac_f32 v225, v210, v106
    v_fmac_f32 v240, v211, v107
    v_mfma_f32_16x16x32_bf16 v[208:211], a[88:91], a[88:91], 0
    v_fmac_f32 v225, v212, v108
    v_fmac_f32 v240, v213, v109
    v_mfma_f32_16x16x32_bf16 v[208:211], a[92:95], a[92:95], v[208:211]
    v_fmac_f32 v225, v214, v110
    v_fmac_f32 v240, v215, v111
    v_mfma_f32_16x16x32_bf16 v[212:215], a[88:91], a[96:99], 0
    v_fmac_f32 v225, v200, v112
    v_fmac_f32 v240, v201, v113
    v_mfma_f32_16x16x32_bf16 v[212:215], a[92:95], a[100:103], v[212:215]
    v_fmac_f32 v225, v202, v114
    v_fmac_f32 v240, v203, v115
    v_mfma_f32_16x16x32_bf16 v[200:203], a[104:107], a[88:91], 0
    v_fmac_f32 v225, v204, v116
    v_mfma_f32_16x16x32_bf16 v[200:203], a[108:111], a[92:95], v[200:203]
    buffer_load_dwordx2 v[28:29], v8, s[28:31], s57 offen offset:2048
    v_mfma_f32_16x16x32_bf16 v[204:207], a[96:99], a[96:99], 0
    v_fmac_f32 v225, v208, v120
    v_fmac_f32 v240, v209, v121
    v_mfma_f32_16x16x32_bf16 v[204:207], a[100:103], a[100:103], v[204:207]
    v_fmac_f32 v225, v210, v122
    v_fmac_f32 v240, v211, v123
    v_mfma_f32_16x16x32_bf16 v[208:211], a[104:107], a[96:99], 0
    v_fmac_f32 v225, v212, v124
    v_fmac_f32 v240, v213, v125
    v_mfma_f32_16x16x32_bf16 v[208:211], a[108:111], a[100:103], v[208:211]
    v_fmac_f32 v225, v214, v126
    v_fmac_f32 v240, v215, v127
    v_mfma_f32_16x16x32_bf16 v[212:215], a[104:107], a[104:107], 0
    v_fmac_f32 v225, v200, v128
    v_mfma_f32_16x16x32_bf16 v[212:215], a[108:111], a[108:111], v[212:215]
    v_fmac_f32 v225, v204, v132
    v_fmac_f32 v240, v205, v133
    v_fmac_f32 v225, v206, v134
    v_fmac_f32 v240, v207, v135
    v_fmac_f32 v225, v208, v136
    s_nop 2
    v_fmac_f32 v225, v212, v140
    v_add_f32 v200, v216, v217
    v_add_f32 v201, v218, v219
    v_add_f32 v202, v223, v224
    v_add_f32 v203, v225, v240
    v_add_f32_dpp v200, v200, v200 row_shr:1 row_mask:0xf bank_mask:0xf
    v_add_f32_dpp v201, v201, v201 row_shr:1 row_mask:0xf bank_mask:0xf
    v_add_f32_dpp v202, v202, v202 row_shr:1 row_mask:0xf bank_mask:0xf
    v_add_f32_dpp v203, v203, v203 row_shr:1 row_mask:0xf bank_mask:0xf
    v_add_f32_dpp v200, v200, v200 row_shr:2 row_mask:0xf bank_mask:0xf
    v_add_f32_dpp v201, v201, v201 row_shr:2 row_mask:0xf bank_mask:0xf
    v_add_f32_dpp v202, v202, v202 row_shr:2 row_mask:0xf bank_mask:0xf
    v_add_f32_dpp v203, v203, v203 row_shr:2 row_mask:0xf bank_mask:0xf
    v_add_f32_dpp v200, v200, v200 row_shr:4 row_mask:0xf bank_mask:0xf
    v_add_f32_dpp v201, v201, v201 row_shr:4 row_mask:0xf bank_mask:0xf
    v_add_f32_dpp v202, v202, v202 row_shr:4 row_mask:0xf bank_mask:0xf
    v_add_f32_dpp v203, v203, v203 row_shr:4 row_mask:0xf bank_mask:0xf
    v_add_f32_dpp v200, v200, v200 row_shr:8 row_mask:0xf bank_mask:0xf
    v_add_f32_dpp v201, v201, v201 row_shr:8 row_mask:0xf bank_mask:0xf
    v_add_f32_dpp v202, v202, v202 row_shr:8 row_mask:0xf bank_mask:0xf
    v_add_f32_dpp v203, v203, v203 row_shr:8 row_mask:0xf bank_mask:0xf
    v_add_f32_dpp v200, v200, v200 row_bcast:15 row_mask:0xa bank_mask:0xf
    v_add_f32_dpp v201, v201, v201 row_bcast:15 row_mask:0xa bank_mask:0xf
    v_add_f32_dpp v202, v202, v202 row_bcast:15 row_mask:0xa bank_mask:0xf
    v_add_f32_dpp v203, v203, v203 row_bcast:15 row_mask:0xa bank_mask:0xf
    v_add_f32_dpp v200, v200, v200 row_bcast:31 row_mask:0xc bank_mask:0xf
    v_add_f32_dpp v201, v201, v201 row_bcast:31 row_mask:0xc bank_mask:0xf
    v_add_f32_dpp v202, v202, v202 row_bcast:31 row_mask:0xc bank_mask:0xf
    v_add_f32_dpp v203, v203, v203 row_bcast:31 row_mask:0xc bank_mask:0xf
    v_readlane_b32 s4, v200, 63
    v_readlane_b32 s5, v201, 63
    v_readlane_b32 s6, v202, 63
    v_readlane_b32 s7, v203, 63
    s_mov_b32 s61, 200000
    s_waitcnt vmcnt(3)
L_poll1:
    v_cmp_gt_u32 vcc, 64, v12
    s_cbranch_vccz L_nopoll1
    s_sleep 4
    global_load_dword v12, v226, s[20:21] sc1
    s_waitcnt vmcnt(0)
    s_sub_u32 s61, s61, 1
    s_cbranch_scc0 L_poll1
L_nopoll1:
    ds_read_b128 a[56:59], v244 offset:14336
    ds_read_b128 a[60:63], v245 offset:14336
    ds_read_b128 a[64:67], v244 offset:16384
    ds_read_b128 a[68:71], v245 offset:16384
    ds_read_b128 a[72:75], v244 offset:18432
    ds_read_b128 a[76:79], v245 offset:18432
    ds_read_b128 a[80:83], v244 offset:20480
    ds_read_b128 a[84:87], v245 offset:20480
    ds_read_b128 a[88:91], v244 offset:22528
    ds_read_b128 a[92:95], v245 offset:22528
    ds_read_b128 a[96:99], v244 offset:24576
    buffer_load_dwordx2 v[30:31], v8, s[28:31], s57 offen offset:3072
    s_add_u32 s57, s57, 1048576
    s_cmp_ge_u32 s57, s58
    s_cselect_b32 s57, 0x40000000, s57
    ds_read_b128 a[100:103], v245 offset:24576
    ds_read_b128 a[104:107], v244 offset:26624
    ds_read_b128 a[108:111], v245 offset:26624
    v_perm_b32 v144, v229, v228, v246
    v_perm_b32 v145, v231, v230, v246
    v_perm_b32 v146, v233, v232, v246
    v_perm_b32 v147, v235, v234, v246
    ds_write_b128 v247, v[144:147] offset:16384
    v_and_b32 v184, 3, v0
    s_movk_i32 s51, 0x1111
    v_mul_lo_u32 v184, v184, s51
    buffer_load_dwordx4 v[128:131], v2, s[8:11], s59 offen offset:0 sc1
    v_cmp_gt_u32 vcc, 256, v2
    v_mov_b32 v3, 0x40000000
    s_nop 0
    v_cndmask_b32 v3, v3, v249, vcc
    v_mov_b32 v192, 0
    v_mov_b32 v193, 0
    v_mov_b32 v194, 0
    v_mov_b32 v195, 0
    v_mov_b32 v196, 0
    v_mov_b32 v197, 0
    v_mov_b32 v198, 0
    buffer_load_dwordx4 v[132:135], v2, s[8:11], s59 offen offset:1024 sc1
    v_mov_b32 v199, 0
    v_mov_b32 v200, 0
    v_mov_b32 v201, 0
    v_mov_b32 v202, 0
    v_mov_b32 v203, 0
    v_mov_b32 v204, 0
    v_mov_b32 v205, 0
    v_mov_b32 v206, 0
    v_mov_b32 v207, 0
    v_mov_b32 v208, 0
    v_mov_b32 v209, 0
    buffer_load_dwordx4 v[136:139], v2, s[8:11], s59 offen offset:2048 sc1
    v_mov_b32 v210, 0
    v_mov_b32 v211, 0
    v_mov_b32 v212, 0
    v_mov_b32 v213, 0
    v_mov_b32 v214, 0
    v_mov_b32 v215, 0
    v_mov_b32 v216, 0
    v_mov_b32 v217, 0
    v_mov_b32 v218, 0
    v_mov_b32 v219, 0
    buffer_load_dwordx4 v[140:143], v2, s[8:11], s59 offen offset:3072 sc1
    s_add_u32 s59, s59, 4096
    v_mov_b32 v220, 0
    v_mov_b32 v221, 0
    v_mov_b32 v222, 0
    v_mov_b32 v223, 0
    v_mov_b32 v224, s68
    v_mov_b32 v225, s69
    v_mov_b32 v226, s70
    v_mov_b32 v227, s71
    v_mov_b32 v228, s68
    v_mov_b32 v229, s69
    v_mov_b32 v230, s70
    v_mov_b32 v231, s71
    v_mov_b32 v232, s68
    v_mov_b32 v233, s69
    v_mov_b32 v234, s70
    v_mov_b32 v235, s71
    v_mov_b32 v236, s68
    v_mov_b32 v237, s69
    v_mov_b32 v238, s70
    v_mov_b32 v239, s71
    v_mov_b32 v240, s68
    v_mov_b32 v241, s69
    v_mov_b32 v242, s70
    v_mov_b32 v243, s71
    v_mov_b32 v244, s68
    v_mov_b32 v245, s69
    v_mov_b32 v246, s70
    v_mov_b32 v247, s71
    v_mov_b32 v248, s68
    v_mov_b32 v249, s69
    v_mov_b32 v250, s70
    v_mov_b32 v251, s71
    v_mov_b32 v252, s68
    v_mov_b32 v253, s69
    v_mov_b32 v254, s70
    v_mov_b32 v255, s71
    s_mov_b32 s56, 0
    s_add_u32 s54, s64, 4096
    s_waitcnt lgkmcnt(0)
    s_barrier
    ds_read_b128 v[144:147], v10 offset:16384
    ds_read_b128 v[148:151], v10 offset:18432
    ds_read_b128 v[152:155], v10 offset:20480
    ds_read_b128 v[156:159], v10 offset:22528
    s_waitcnt lgkmcnt(0)
    v_mfma_f32_16x16x32_bf16 v[80:83], v[144:147], a[0:3], 0
    v_mfma_f32_16x16x32_bf16 v[80:83], v[148:151], a[4:7], v[80:83]
    buffer_load_dwordx2 v[16:17], v8, s[28:31], s57 offen offset:0
    v_mfma_f32_16x16x32_bf16 v[80:83], v[152:155], a[128:131], v[80:83]
    v_mfma_f32_16x16x32_bf16 v[80:83], v[156:159], a[132:135], v[80:83]
    v_mfma_f32_16x16x32_bf16 v[84:87], v[144:147], a[8:11], 0
    v_mfma_f32_16x16x32_bf16 v[84:87], v[148:151], a[12:15], v[84:87]
    v_mfma_f32_16x16x32_bf16 v[84:87], v[152:155], a[136:139], v[84:87]
    v_mfma_f32_16x16x32_bf16 v[84:87], v[156:159], a[140:143], v[84:87]
    v_mfma_f32_16x16x32_bf16 v[88:91], v[144:147], a[16:19], 0
    v_mfma_f32_16x16x32_bf16 v[88:91], v[148:151], a[20:23], v[88:91]
    v_mfma_f32_16x16x32_bf16 v[88:91], v[152:155], a[144:147], v[88:91]
    v_mfma_f32_16x16x32_bf16 v[88:91], v[156:159], a[148:151], v[88:91]
    v_mfma_f32_16x16x32_bf16 v[92:95], v[144:147], a[24:27], 0
    v_cvt_pk_bf16_f32 v80, v80, v81
    v_cvt_pk_bf16_f32 v81, v82, v83
    v_mfma_f32_16x16x32_bf16 v[92:95], v[148:151], a[28:31], v[92:95]
    v_mfma_f32_16x16x32_bf16 v[92:95], v[152:155], a[152:155], v[92:95]
    ds_write_b64 v13, v[80:81] offset:0
    v_mfma_f32_16x16x32_bf16 v[92:95], v[156:159], a[156:159], v[92:95]
    v_mfma_f32_16x16x32_bf16 v[80:83], v[144:147], a[32:35], 0
    v_cvt_pk_bf16_f32 v84, v84, v85
    v_cvt_pk_bf16_f32 v85, v86, v87
    v_mfma_f32_16x16x32_bf16 v[80:83], v[148:151], a[36:39], v[80:83]
    v_mfma_f32_16x16x32_bf16 v[80:83], v[152:155], a[160:163], v[80:83]
    ds_write_b64 v13, v[84:85] offset:512
    v_mfma_f32_16x16x32_bf16 v[80:83], v[156:159], a[164:167], v[80:83]
    v_mfma_f32_16x16x32_bf16 v[84:87], v[144:147], a[40:43], 0
    v_cvt_pk_bf16_f32 v88, v88, v89
    v_cvt_pk_bf16_f32 v89, v90, v91
    v_mfma_f32_16x16x32_bf16 v[84:87], v[148:151], a[44:47], v[84:87]
    v_mfma_f32_16x16x32_bf16 v[84:87], v[152:155], a[168:171], v[84:87]
    ds_write_b64 v13, v[88:89] offset:1024
    v_mfma_f32_16x16x32_bf16 v[84:87], v[156:159], a[172:175], v[84:87]
    v_mfma_f32_16x16x32_bf16 v[88:91], v[144:147], a[48:51], 0
    v_cvt_pk_bf16_f32 v92, v92, v93
    v_cvt_pk_bf16_f32 v93, v94, v95
    v_mfma_f32_16x16x32_bf16 v[88:91], v[148:151], a[52:55], v[88:91]
    v_mfma_f32_16x16x32_bf16 v[88:91], v[152:155], a[176:179], v[88:91]
    ds_write_b64 v13, v[92:93] offset:1536
    v_mfma_f32_16x16x32_bf16 v[88:91], v[156:159], a[180:183], v[88:91]
    v_mfma_f32_16x16x32_bf16 v[92:95], v[144:147], a[56:59], 0
    v_cvt_pk_bf16_f32 v80, v80, v81
    v_cvt_pk_bf16_f32 v81, v82, v83
    v_mfma_f32_16x16x32_bf16 v[92:95], v[148:151], a[60:63], v[92:95]
    buffer_load_dwordx2 v[18:19], v8, s[28:31], s57 offen offset:1024
    v_mfma_f32_16x16x32_bf16 v[92:95], v[152:155], a[184:187], v[92:95]
    ds_write_b64 v13, v[80:81] offset:2048
    v_mfma_f32_16x16x32_bf16 v[92:95], v[156:159], a[188:191], v[92:95]
    v_mfma_f32_16x16x32_bf16 v[80:83], v[144:147], a[64:67], 0
    v_cvt_pk_bf16_f32 v84, v84, v85
    v_cvt_pk_bf16_f32 v85, v86, v87
    v_mfma_f32_16x16x32_bf16 v[80:83], v[148:151], a[68:71], v[80:83]
    v_mfma_f32_16x16x32_bf16 v[80:83], v[152:155], a[192:195], v[80:83]
    ds_write_b64 v13, v[84:85] offset:2560
    v_mfma_f32_16x16x32_bf16 v[80:83], v[156:159], a[196:199], v[80:83]
    v_mfma_f32_16x16x32_bf16 v[84:87], v[144:147], a[72:75], 0
    v_cvt_pk_bf16_f32 v88, v88, v89
    v_cvt_pk_bf16_f32 v89, v90, v91
    v_mfma_f32_16x16x32_bf16 v[84:87], v[148:151], a[76:79], v[84:87]
    s_waitcnt vmcnt(6)
    v_mfma_f32_16x16x32_bf16 v[84:87], v[152:155], a[200:203], v[84:87]
    ds_write_b64 v13, v[88:89] offset:3072
    v_mfma_f32_16x16x32_bf16 v[84:87], v[156:159], a[204:207], v[84:87]
    v_perm_b32 v176, v26, v24, s62
    v_mfma_f32_16x16x32_bf16 v[88:91], v[144:147], a[80:83], 0
    v_cvt_pk_bf16_f32 v92, v92, v93
    v_cvt_pk_bf16_f32 v93, v94, v95
    v_mfma_f32_16x16x32_bf16 v[88:91], v[148:151], a[84:87], v[88:91]
    v_perm_b32 v177, v30, v28, s62
    v_mfma_f32_16x16x32_bf16 v[88:91], v[152:155], a[208:211], v[88:91]
    ds_write_b64 v13, v[92:93] offset:3584
    v_mfma_f32_16x16x32_bf16 v[88:91], v[156:159], a[212:215], v[88:91]
    ds_write_b64 v11, v[176:177] offset:0
    v_mfma_f32_16x16x32_bf16 v[92:95], v[144:147], a[88:91], 0
    v_cvt_pk_bf16_f32 v80, v80, v81
    v_cvt_pk_bf16_f32 v81, v82, v83
    v_mfma_f32_16x16x32_bf16 v[92:95], v[148:151], a[92:95], v[92:95]
    v_perm_b32 v178, v26, v24, s63
    v_mfma_f32_16x16x32_bf16 v[92:95], v[152:155], a[216:219], v[92:95]
    ds_write_b64 v13, v[80:81] offset:4096
    v_mfma_f32_16x16x32_bf16 v[92:95], v[156:159], a[220:223], v[92:95]
    v_perm_b32 v179, v30, v28, s63
    v_mfma_f32_16x16x32_bf16 v[80:83], v[144:147], a[96:99], 0
    v_cvt_pk_bf16_f32 v84, v84, v85
    v_cvt_pk_bf16_f32 v85, v86, v87
    v_mfma_f32_16x16x32_bf16 v[80:83], v[148:151], a[100:103], v[80:83]
    ds_write_b64 v11, v[178:179] offset:1024
    v_mfma_f32_16x16x32_bf16 v[80:83], v[152:155], a[224:227], v[80:83]
    ds_write_b64 v13, v[84:85] offset:4608
    v_mfma_f32_16x16x32_bf16 v[80:83], v[156:159], a[228:231], v[80:83]
    v_perm_b32 v180, v27, v25, s62
    v_mfma_f32_16x16x32_bf16 v[84:87], v[144:147], a[104:107], 0
    v_cvt_pk_bf16_f32 v88, v88, v89
    v_cvt_pk_bf16_f32 v89, v90, v91
    v_mfma_f32_16x16x32_bf16 v[84:87], v[148:151], a[108:111], v[84:87]
    v_perm_b32 v181, v31, v29, s62
    v_mfma_f32_16x16x32_bf16 v[84:87], v[152:155], a[232:235], v[84:87]
    ds_write_b64 v13, v[88:89] offset:5120
    v_mfma_f32_16x16x32_bf16 v[84:87], v[156:159], a[236:239], v[84:87]
    ds_write_b64 v11, v[180:181] offset:16
    v_mfma_f32_16x16x32_bf16 v[88:91], v[144:147], a[112:115], 0
    v_cvt_pk_bf16_f32 v92, v92, v93
    v_cvt_pk_bf16_f32 v93, v94, v95
    v_mfma_f32_16x16x32_bf16 v[88:91], v[148:151], a[116:119], v[88:91]
    v_perm_b32 v182, v27, v25, s63
    v_mfma_f32_16x16x32_bf16 v[88:91], v[152:155], a[240:243], v[88:91]
    ds_write_b64 v13, v[92:93] offset:5632
    v_mfma_f32_16x16x32_bf16 v[88:91], v[156:159], a[244:247], v[88:91]
    v_perm_b32 v183, v31, v29, s63
    v_mfma_f32_16x16x32_bf16 v[92:95], v[144:147], a[120:123], 0
    v_cvt_pk_bf16_f32 v80, v80, v81
    v_cvt_pk_bf16_f32 v81, v82, v83
    v_mfma_f32_16x16x32_bf16 v[92:95], v[148:151], a[124:127], v[92:95]
    ds_write_b64 v11, v[182:183] offset:1040
    v_mfma_f32_16x16x32_bf16 v[92:95], v[152:155], a[248:251], v[92:95]
    ds_write_b64 v13, v[80:81] offset:6144
    v_mfma_f32_16x16x32_bf16 v[92:95], v[156:159], a[252:255], v[92:95]
    v_xor_b32 v11, 0x2000, v11
    v_cvt_pk_bf16_f32 v84, v84, v85
    v_cvt_pk_bf16_f32 v85, v86, v87
    ds_write_b64 v13, v[84:85] offset:6656
    v_cvt_pk_bf16_f32 v88, v88, v89
    v_cvt_pk_bf16_f32 v89, v90, v91
    ds_write_b64 v13, v[88:89] offset:7168
    s_nop 0
    v_cvt_pk_bf16_f32 v92, v92, v93
    v_cvt_pk_bf16_f32 v93, v94, v95
    ds_write_b64 v13, v[92:93] offset:7680
    s_waitcnt lgkmcnt(0)
    s_barrier
    ds_read_b128 v[144:147], v10 offset:0
    ds_read_b128 v[148:151], v10 offset:2048
    ds_read_b128 v[152:155], v10 offset:4096
    ds_read_b128 v[156:159], v10 offset:6144
    ds_read_b128 v[160:163], v10 offset:1024
    ds_read_b128 v[164:167], v10 offset:3072
    ds_read_b128 v[168:171], v10 offset:5120
    ds_read_b128 v[172:175], v10 offset:7168
    v_xor_b32 v10, 0x2000, v10
    s_waitcnt vmcnt(5)
    v_lshlrev_b32_sdwa v64, 3, v128 dst_sel:DWORD dst_unused:UNUSED_PAD src0_sel:DWORD src1_sel:WORD_0
    v_lshlrev_b32_sdwa v65, 3, v128 dst_sel:DWORD dst_unused:UNUSED_PAD src0_sel:DWORD src1_sel:WORD_1
    v_lshlrev_b32_sdwa v66, 3, v129 dst_sel:DWORD dst_unused:UNUSED_PAD src0_sel:DWORD src1_sel:WORD_0
    ds_read_b64 v[104:105], v64
    v_lshlrev_b32_sdwa v67, 3, v129 dst_sel:DWORD dst_unused:UNUSED_PAD src0_sel:DWORD src1_sel:WORD_1
    ds_read_b64 v[106:107], v65
    v_lshlrev_b32_sdwa v68, 3, v130 dst_sel:DWORD dst_unused:UNUSED_PAD src0_sel:DWORD src1_sel:WORD_0
    ds_read_b64 v[108:109], v66
    v_lshlrev_b32_sdwa v69, 3, v130 dst_sel:DWORD dst_unused:UNUSED_PAD src0_sel:DWORD src1_sel:WORD_1
    ds_read_b64 v[110:111], v67
    v_lshlrev_b32_sdwa v70, 3, v131 dst_sel:DWORD dst_unused:UNUSED_PAD src0_sel:DWORD src1_sel:WORD_0
    s_waitcnt vmcnt(4)
    ds_read_b64 v[112:113], v68
    v_lshlrev_b32_sdwa v71, 3, v131 dst_sel:DWORD dst_unused:UNUSED_PAD src0_sel:DWORD src1_sel:WORD_1
    s_waitcnt lgkmcnt(9)
    v_mfma_f32_16x16x32_bf16 v[80:83], a[0:3], v[144:147], 0
    buffer_load_dwordx2 v[20:21], v8, s[28:31], s57 offen offset:2048
    ds_read_b64 v[114:115], v69
    v_lshlrev_b32_sdwa v72, 3, v132 dst_sel:DWORD dst_unused:UNUSED_PAD src0_sel:DWORD src1_sel:WORD_0
    v_mfma_f32_16x16x32_bf16 v[80:83], a[4:7], v[148:151], v[80:83]
    ds_read_b64 v[116:117], v70
    v_lshlrev_b32_sdwa v73, 3, v132 dst_sel:DWORD dst_unused:UNUSED_PAD src0_sel:DWORD src1_sel:WORD_1
    v_mfma_f32_16x16x32_bf16 v[80:83], a[128:131], v[152:155], v[80:83]
    ds_read_b64 v[118:119], v71
    v_lshlrev_b32_sdwa v74, 3, v133 dst_sel:DWORD dst_unused:UNUSED_PAD src0_sel:DWORD src1_sel:WORD_0
    v_mfma_f32_16x16x32_bf16 v[80:83], a[132:135], v[156:159], v[80:83]
    ds_read_b64 v[120:121], v72
    v_lshlrev_b32_sdwa v75, 3, v133 dst_sel:DWORD dst_unused:UNUSED_PAD src0_sel:DWORD src1_sel:WORD_1
    s_waitcnt lgkmcnt(9)
    v_mfma_f32_16x16x32_bf16 v[84:87], a[0:3], v[160:163], 0
    ds_read_b64 v[122:123], v73
    v_lshlrev_b32_sdwa v76, 3, v134 dst_sel:DWORD dst_unused:UNUSED_PAD src0_sel:DWORD src1_sel:WORD_0
    v_mfma_f32_16x16x32_bf16 v[84:87], a[4:7], v[164:167], v[84:87]
    ds_read_b64 v[124:125], v74
    v_lshlrev_b32_sdwa v77, 3, v134 dst_sel:DWORD dst_unused:UNUSED_PAD src0_sel:DWORD src1_sel:WORD_1
    v_mfma_f32_16x16x32_bf16 v[84:87], a[128:131], v[168:171], v[84:87]
    ds_read_b64 v[126:127], v75
    v_lshlrev_b32_sdwa v78, 3, v135 dst_sel:DWORD dst_unused:UNUSED_PAD src0_sel:DWORD src1_sel:WORD_0
    v_mfma_f32_16x16x32_bf16 v[84:87], a[132:135], v[172:175], v[84:87]
    s_waitcnt vmcnt(4)
    s_waitcnt lgkmcnt(8)
    v_smfmac_f32_16x16x64_bf16 v[224:227], v[4:7], v[104:111], v184
    ds_read_b64 v[104:105], v76
    v_lshlrev_b32_sdwa v79, 3, v135 dst_sel:DWORD dst_unused:UNUSED_PAD src0_sel:DWORD src1_sel:WORD_1
    v_mfma_f32_16x16x32_bf16 v[88:91], a[8:11], v[144:147], 0
    ds_read_b64 v[106:107], v77
    v_lshlrev_b32_sdwa v64, 3, v136 dst_sel:DWORD dst_unused:UNUSED_PAD src0_sel:DWORD src1_sel:WORD_0
    v_mfma_f32_16x16x32_bf16 v[88:91], a[12:15], v[148:151], v[88:91]
    ds_read_b64 v[108:109], v78
    v_lshlrev_b32_sdwa v65, 3, v136 dst_sel:DWORD dst_unused:UNUSED_PAD src0_sel:DWORD src1_sel:WORD_1
    v_mfma_f32_16x16x32_bf16 v[88:91], a[136:139], v[152:155], v[88:91]
    ds_read_b64 v[110:111], v79
    v_lshlrev_b32_sdwa v66, 3, v137 dst_sel:DWORD dst_unused:UNUSED_PAD src0_sel:DWORD src1_sel:WORD_0
    v_mfma_f32_16x16x32_bf16 v[88:91], a[140:143], v[156:159], v[88:91]
    s_waitcnt lgkmcnt(8)
    v_smfmac_f32_16x16x64_bf16 v[228:231], v[4:7], v[112:119], v184
    ds_read_b64 v[112:113], v64
    v_lshlrev_b32_sdwa v67, 3, v137 dst_sel:DWORD dst_unused:UNUSED_PAD src0_sel:DWORD src1_sel:WORD_1
    v_mfma_f32_16x16x32_bf16 v[92:95], a[8:11], v[160:163], 0
    ds_read_b64 v[114:115], v65
    v_lshlrev_b32_sdwa v68, 3, v138 dst_sel:DWORD dst_unused:UNUSED_PAD src0_sel:DWORD src1_sel:WORD_0
    v_mfma_f32_16x16x32_bf16 v[92:95], a[12:15], v[164:167], v[92:95]
    ds_read_b64 v[116:117], v66
    v_lshlrev_b32_sdwa v69, 3, v138 dst_sel:DWORD dst_unused:UNUSED_PAD src0_sel:DWORD src1_sel:WORD_1
    v_mfma_f32_16x16x32_bf16 v[92:95], a[136:139], v[168:171], v[92:95]
    ds_read_b64 v[118:119], v67
    v_lshlrev_b32_sdwa v70, 3, v139 dst_sel:DWORD dst_unused:UNUSED_PAD src0_sel:DWORD src1_sel:WORD_0
    v_mfma_f32_16x16x32_bf16 v[92:95], a[140:143], v[172:175], v[92:95]
    s_waitcnt vmcnt(3)
    s_waitcnt lgkmcnt(8)
    v_smfmac_f32_16x16x64_bf16 v[232:235], v[4:7], v[120:127], v184
    ds_read_b64 v[120:121], v68
    v_lshlrev_b32_sdwa v71, 3, v139 dst_sel:DWORD dst_unused:UNUSED_PAD src0_sel:DWORD src1_sel:WORD_1
    v_mfma_f32_16x16x32_bf16 v[96:99], a[16:19], v[144:147], 0
    ds_read_b64 v[122:123], v69
    v_lshlrev_b32_sdwa v72, 3, v140 dst_sel:DWORD dst_unused:UNUSED_PAD src0_sel:DWORD src1_sel:WORD_0
    v_cvt_pk_bf16_f32 v80, v80, v84
    v_mfma_f32_16x16x32_bf16 v[96:99], a[20:23], v[148:151], v[96:99]
    ds_read_b64 v[124:125], v70
    v_lshlrev_b32_sdwa v73, 3, v140 dst_sel:DWORD dst_unused:UNUSED_PAD src0_sel:DWORD src1_sel:WORD_1
    v_cvt_pk_bf16_f32 v81, v81, v85
    v_mfma_f32_16x16x32_bf16 v[96:99], a[144:147], v[152:155], v[96:99]
    ds_read_b64 v[126:127], v71
    v_lshlrev_b32_sdwa v74, 3, v141 dst_sel:DWORD dst_unused:UNUSED_PAD src0_sel:DWORD src1_sel:WORD_0
    v_mfma_f32_16x16x32_bf16 v[96:99], a[148:151], v[156:159], v[96:99]
    ds_write2st64_b32 v1, v80, v81 offset0:0 offset1:1
    s_waitcnt lgkmcnt(9)
    v_smfmac_f32_16x16x64_bf16 v[236:239], v[4:7], v[104:111], v184
    ds_read_b64 v[104:105], v72
    v_lshlrev_b32_sdwa v75, 3, v141 dst_sel:DWORD dst_unused:UNUSED_PAD src0_sel:DWORD src1_sel:WORD_1
    v_mfma_f32_16x16x32_bf16 v[100:103], a[16:19], v[160:163], 0
    ds_read_b64 v[106:107], v73
    v_lshlrev_b32_sdwa v76, 3, v142 dst_sel:DWORD dst_unused:UNUSED_PAD src0_sel:DWORD src1_sel:WORD_0
    v_cvt_pk_bf16_f32 v82, v82, v86
    v_mfma_f32_16x16x32_bf16 v[100:103], a[20:23], v[164:167], v[100:103]
    ds_read_b64 v[108:109], v74
    v_lshlrev_b32_sdwa v77, 3, v142 dst_sel:DWORD dst_unused:UNUSED_PAD src0_sel:DWORD src1_sel:WORD_1
    v_cvt_pk_bf16_f32 v83, v83, v87
    v_mfma_f32_16x16x32_bf16 v[100:103], a[144:147], v[168:171], v[100:103]
    ds_read_b64 v[110:111], v75
    v_lshlrev_b32_sdwa v78, 3, v143 dst_sel:DWORD dst_unused:UNUSED_PAD src0_sel:DWORD src1_sel:WORD_0
    v_mfma_f32_16x16x32_bf16 v[100:103], a[148:151], v[172:175], v[100:103]
    ds_write2st64_b32 v1, v82, v83 offset0:2 offset1:3
    s_waitcnt lgkmcnt(10)
    v_smfmac_f32_16x16x64_bf16 v[240:243], v[4:7], v[112:119], v184
    ds_read_b64 v[112:113], v76
    v_lshlrev_b32_sdwa v79, 3, v143 dst_sel:DWORD dst_unused:UNUSED_PAD src0_sel:DWORD src1_sel:WORD_1
    v_mfma_f32_16x16x32_bf16 v[80:83], a[24:27], v[144:147], 0
    buffer_load_dwordx2 v[22:23], v8, s[28:31], s57 offen offset:3072
    s_add_u32 s57, s57, 1048576
    s_cmp_ge_u32 s57, s58
    s_cselect_b32 s57, 0x40000000, s57
    ds_read_b64 v[114:115], v77
    v_cvt_pk_bf16_f32 v88, v88, v92
    v_mfma_f32_16x16x32_bf16 v[80:83], a[28:31], v[148:151], v[80:83]
    ds_read_b64 v[116:117], v78
    v_cvt_pk_bf16_f32 v89, v89, v93
    v_mfma_f32_16x16x32_bf16 v[80:83], a[152:155], v[152:155], v[80:83]
    ds_read_b64 v[118:119], v79
    v_mfma_f32_16x16x32_bf16 v[80:83], a[156:159], v[156:159], v[80:83]
    ds_write2st64_b32 v1, v88, v89 offset0:4 offset1:5
    s_waitcnt lgkmcnt(11)
    v_smfmac_f32_16x16x64_bf16 v[244:247], v[4:7], v[120:127], v184
    v_mfma_f32_16x16x32_bf16 v[84:87], a[24:27], v[160:163], 0
    v_cvt_pk_bf16_f32 v90, v90, v94
    v_mfma_f32_16x16x32_bf16 v[84:87], a[28:31], v[164:167], v[84:87]
    v_cvt_pk_bf16_f32 v91, v91, v95
    v_mfma_f32_16x16x32_bf16 v[84:87], a[152:155], v[168:171], v[84:87]
    v_mfma_f32_16x16x32_bf16 v[84:87], a[156:159], v[172:175], v[84:87]
    ds_write2st64_b32 v1, v90, v91 offset0:6 offset1:7
    s_waitcnt lgkmcnt(7)
    v_smfmac_f32_16x16x64_bf16 v[248:251], v[4:7], v[104:111], v184
    v_mfma_f32_16x16x32_bf16 v[88:91], a[32:35], v[144:147], 0
    buffer_load_dwordx4 v[32:35], v2, s[8:11], s59 offen offset:0 sc1
    v_cvt_pk_bf16_f32 v96, v96, v100
    v_mfma_f32_16x16x32_bf16 v[88:91], a[36:39], v[148:151], v[88:91]
    v_cvt_pk_bf16_f32 v97, v97, v101
    v_mfma_f32_16x16x32_bf16 v[88:91], a[160:163], v[152:155], v[88:91]
    v_mfma_f32_16x16x32_bf16 v[88:91], a[164:167], v[156:159], v[88:91]
    ds_write2st64_b32 v1, v96, v97 offset0:8 offset1:9
    s_waitcnt lgkmcnt(3)
    v_smfmac_f32_16x16x64_bf16 v[252:255], v[4:7], v[112:119], v184
    v_mfma_f32_16x16x32_bf16 v[92:95], a[32:35], v[160:163], 0
    v_cvt_pk_bf16_f32 v98, v98, v102
    v_mfma_f32_16x16x32_bf16 v[92:95], a[36:39], v[164:167], v[92:95]
    v_cvt_pk_bf16_f32 v99, v99, v103
    v_mfma_f32_16x16x32_bf16 v[92:95], a[160:163], v[168:171], v[92:95]
    v_mfma_f32_16x16x32_bf16 v[92:95], a[164:167], v[172:175], v[92:95]
    ds_write2st64_b32 v1, v98, v99 offset0:10 offset1:11
    v_mfma_f32_16x16x32_bf16 v[96:99], a[40:43], v[144:147], 0
    buffer_load_dwordx4 v[36:39], v2, s[8:11], s59 offen offset:1024 sc1
    v_cvt_pk_bf16_f32 v80, v80, v84
    v_mfma_f32_16x16x32_bf16 v[96:99], a[44:47], v[148:151], v[96:99]
    v_cvt_pk_bf16_f32 v81, v81, v85
    v_mfma_f32_16x16x32_bf16 v[96:99], a[168:171], v[152:155], v[96:99]
    v_mfma_f32_16x16x32_bf16 v[96:99], a[172:175], v[156:159], v[96:99]
    ds_write2st64_b32 v1, v80, v81 offset0:12 offset1:13
    v_mfma_f32_16x16x32_bf16 v[100:103], a[40:43], v[160:163], 0
    v_cvt_pk_bf16_f32 v82, v82, v86
    v_mfma_f32_16x16x32_bf16 v[100:103], a[44:47], v[164:167], v[100:103]
    v_cvt_pk_bf16_f32 v83, v83, v87
    v_mfma_f32_16x16x32_bf16 v[100:103], a[168:171], v[168:171], v[100:103]
    v_mfma_f32_16x16x32_bf16 v[100:103], a[172:175], v[172:175], v[100:103]
    ds_write2st64_b32 v1, v82, v83 offset0:14 offset1:15
    v_mfma_f32_16x16x32_bf16 v[80:83], a[48:51], v[144:147], 0
    buffer_load_dwordx2 v[24:25], v8, s[28:31], s57 offen offset:0
    v_cvt_pk_bf16_f32 v88, v88, v92
    v_mfma_f32_16x16x32_bf16 v[80:83], a[52:55], v[148:151], v[80:83]
    v_cvt_pk_bf16_f32 v89, v89, v93
    v_mfma_f32_16x16x32_bf16 v[80:83], a[176:179], v[152:155], v[80:83]
    v_mfma_f32_16x16x32_bf16 v[80:83], a[180:183], v[156:159], v[80:83]
    ds_write2st64_b32 v1, v88, v89 offset0:16 offset1:17
    v_mfma_f32_16x16x32_bf16 v[84:87], a[48:51], v[160:163], 0
    v_cvt_pk_bf16_f32 v90, v90, v94
    v_mfma_f32_16x16x32_bf16 v[84:87], a[52:55], v[164:167], v[84:87]
    v_cvt_pk_bf16_f32 v91, v91, v95
    v_mfma_f32_16x16x32_bf16 v[84:87], a[176:179], v[168:171], v[84:87]
    v_mfma_f32_16x16x32_bf16 v[84:87], a[180:183], v[172:175], v[84:87]
    ds_write2st64_b32 v1, v90, v91 offset0:18 offset1:19
    v_mfma_f32_16x16x32_bf16 v[88:91], a[56:59], v[144:147], 0
    buffer_load_dwordx4 v[40:43], v2, s[8:11], s59 offen offset:2048 sc1
    v_cvt_pk_bf16_f32 v96, v96, v100
    v_mfma_f32_16x16x32_bf16 v[88:91], a[60:63], v[148:151], v[88:91]
    v_cvt_pk_bf16_f32 v97, v97, v101
    v_mfma_f32_16x16x32_bf16 v[88:91], a[184:187], v[152:155], v[88:91]
    v_mfma_f32_16x16x32_bf16 v[88:91], a[188:191], v[156:159], v[88:91]
    ds_write2st64_b32 v1, v96, v97 offset0:20 offset1:21
    v_mfma_f32_16x16x32_bf16 v[92:95], a[56:59], v[160:163], 0
    v_cvt_pk_bf16_f32 v98, v98, v102
    v_mfma_f32_16x16x32_bf16 v[92:95], a[60:63], v[164:167], v[92:95]
    v_cvt_pk_bf16_f32 v99, v99, v103
    v_mfma_f32_16x16x32_bf16 v[92:95], a[184:187], v[168:171], v[92:95]
    v_mfma_f32_16x16x32_bf16 v[92:95], a[188:191], v[172:175], v[92:95]
    ds_write2st64_b32 v1, v98, v99 offset0:22 offset1:23
    v_mfma_f32_16x16x32_bf16 v[96:99], a[64:67], v[144:147], 0
    buffer_load_dwordx4 v[44:47], v2, s[8:11], s59 offen offset:3072 sc1
    s_add_u32 s59, s59, 4096
    v_cvt_pk_bf16_f32 v80, v80, v84
    v_mfma_f32_16x16x32_bf16 v[96:99], a[68:71], v[148:151], v[96:99]
    v_cvt_pk_bf16_f32 v81, v81, v85
    v_mfma_f32_16x16x32_bf16 v[96:99], a[192:195], v[152:155], v[96:99]
    v_mfma_f32_16x16x32_bf16 v[96:99], a[196:199], v[156:159], v[96:99]
    ds_write2st64_b32 v1, v80, v81 offset0:24 offset1:25
    v_mfma_f32_16x16x32_bf16 v[100:103], a[64:67], v[160:163], 0
    v_cvt_pk_bf16_f32 v82, v82, v86
    v_mfma_f32_16x16x32_bf16 v[100:103], a[68:71], v[164:167], v[100:103]
    v_cvt_pk_bf16_f32 v83, v83, v87
    v_mfma_f32_16x16x32_bf16 v[100:103], a[192:195], v[168:171], v[100:103]
    v_mfma_f32_16x16x32_bf16 v[100:103], a[196:199], v[172:175], v[100:103]
    ds_write2st64_b32 v1, v82, v83 offset0:26 offset1:27
    v_mfma_f32_16x16x32_bf16 v[80:83], a[72:75], v[144:147], 0
    buffer_load_dwordx4 v[48:51], v2, s[8:11], s59 offen offset:0 sc1
    v_cvt_pk_bf16_f32 v88, v88, v92
    v_mfma_f32_16x16x32_bf16 v[80:83], a[76:79], v[148:151], v[80:83]
    v_cvt_pk_bf16_f32 v89, v89, v93
    v_mfma_f32_16x16x32_bf16 v[80:83], a[200:203], v[152:155], v[80:83]
    v_mfma_f32_16x16x32_bf16 v[80:83], a[204:207], v[156:159], v[80:83]
    ds_write2st64_b32 v1, v88, v89 offset0:28 offset1:29
    v_mfma_f32_16x16x32_bf16 v[84:87], a[72:75], v[160:163], 0
    v_cvt_pk_bf16_f32 v90, v90, v94
    v_mfma_f32_16x16x32_bf16 v[84:87], a[76:79], v[164:167], v[84:87]
    v_cvt_pk_bf16_f32 v91, v91, v95
    v_mfma_f32_16x16x32_bf16 v[84:87], a[200:203], v[168:171], v[84:87]
    v_mfma_f32_16x16x32_bf16 v[84:87], a[204:207], v[172:175], v[84:87]
    ds_write2st64_b32 v1, v90, v91 offset0:30 offset1:31
    v_mfma_f32_16x16x32_bf16 v[88:91], a[80:83], v[144:147], 0
    buffer_load_dwordx2 v[26:27], v8, s[28:31], s57 offen offset:1024
    v_cvt_pk_bf16_f32 v96, v96, v100
    v_mfma_f32_16x16x32_bf16 v[88:91], a[84:87], v[148:151], v[88:91]
    v_cvt_pk_bf16_f32 v97, v97, v101
    v_mfma_f32_16x16x32_bf16 v[88:91], a[208:211], v[152:155], v[88:91]
    v_mfma_f32_16x16x32_bf16 v[88:91], a[212:215], v[156:159], v[88:91]
    ds_write2st64_b32 v1, v96, v97 offset0:32 offset1:33
    v_mfma_f32_16x16x32_bf16 v[92:95], a[80:83], v[160:163], 0
    v_cvt_pk_bf16_f32 v98, v98, v102
    v_mfma_f32_16x16x32_bf16 v[92:95], a[84:87], v[164:167], v[92:95]
    v_cvt_pk_bf16_f32 v99, v99, v103
    v_mfma_f32_16x16x32_bf16 v[92:95], a[208:211], v[168:171], v[92:95]
    v_mfma_f32_16x16x32_bf16 v[92:95], a[212:215], v[172:175], v[92:95]
    ds_write2st64_b32 v1, v98, v99 offset0:34 offset1:35
    v_mfma_f32_16x16x32_bf16 v[96:99], a[88:91], v[144:147], 0
    buffer_load_dwordx4 v[52:55], v2, s[8:11], s59 offen offset:1024 sc1
    v_cvt_pk_bf16_f32 v80, v80, v84
    v_mfma_f32_16x16x32_bf16 v[96:99], a[92:95], v[148:151], v[96:99]
    v_cvt_pk_bf16_f32 v81, v81, v85
    v_mfma_f32_16x16x32_bf16 v[96:99], a[216:219], v[152:155], v[96:99]
    v_mfma_f32_16x16x32_bf16 v[96:99], a[220:223], v[156:159], v[96:99]
    ds_write2st64_b32 v1, v80, v81 offset0:36 offset1:37
    v_mfma_f32_16x16x32_bf16 v[100:103], a[88:91], v[160:163], 0
    v_cvt_pk_bf16_f32 v82, v82, v86
    v_mfma_f32_16x16x32_bf16 v[100:103], a[92:95], v[164:167], v[100:103]
    v_cvt_pk_bf16_f32 v83, v83, v87
    v_mfma_f32_16x16x32_bf16 v[100:103], a[216:219], v[168:171], v[100:103]
    v_mfma_f32_16x16x32_bf16 v[100:103], a[220:223], v[172:175], v[100:103]
    ds_write2st64_b32 v1, v82, v83 offset0:38 offset1:39
    v_mfma_f32_16x16x32_bf16 v[80:83], a[96:99], v[144:147], 0
    buffer_load_dwordx4 v[56:59], v2, s[8:11], s59 offen offset:2048 sc1
    v_cvt_pk_bf16_f32 v88, v88, v92
    v_mfma_f32_16x16x32_bf16 v[80:83], a[100:103], v[148:151], v[80:83]
    v_cvt_pk_bf16_f32 v89, v89, v93
    v_mfma_f32_16x16x32_bf16 v[80:83], a[224:227], v[152:155], v[80:83]
    v_mfma_f32_16x16x32_bf16 v[80:83], a[228:231], v[156:159], v[80:83]
    ds_write2st64_b32 v1, v88, v89 offset0:40 offset1:41
    v_mfma_f32_16x16x32_bf16 v[84:87], a[96:99], v[160:163], 0
    v_cvt_pk_bf16_f32 v90, v90, v94
    v_mfma_f32_16x16x32_bf16 v[84:87], a[100:103], v[164:167], v[84:87]
    v_cvt_pk_bf16_f32 v91, v91, v95
    v_mfma_f32_16x16x32_bf16 v[84:87], a[224:227], v[168:171], v[84:87]
    v_mfma_f32_16x16x32_bf16 v[84:87], a[228:231], v[172:175], v[84:87]
    ds_write2st64_b32 v1, v90, v91 offset0:42 offset1:43
    v_mfma_f32_16x16x32_bf16 v[88:91], a[104:107], v[144:147], 0
    buffer_load_dwordx4 v[60:63], v2, s[8:11], s59 offen offset:3072 sc1
    s_add_u32 s59, s59, 4096
    v_cvt_pk_bf16_f32 v96, v96, v100
    v_mfma_f32_16x16x32_bf16 v[88:91], a[108:111], v[148:151], v[88:91]
    v_cvt_pk_bf16_f32 v97, v97, v101
    v_mfma_f32_16x16x32_bf16 v[88:91], a[232:235], v[152:155], v[88:91]
    v_mfma_f32_16x16x32_bf16 v[88:91], a[236:239], v[156:159], v[88:91]
    ds_write2st64_b32 v1, v96, v97 offset0:44 offset1:45
    v_mfma_f32_16x16x32_bf16 v[92:95], a[104:107], v[160:163], 0
    v_cvt_pk_bf16_f32 v98, v98, v102
    v_mfma_f32_16x16x32_bf16 v[92:95], a[108:111], v[164:167], v[92:95]
    v_cvt_pk_bf16_f32 v99, v99, v103
    v_mfma_f32_16x16x32_bf16 v[92:95], a[232:235], v[168:171], v[92:95]
    v_mfma_f32_16x16x32_bf16 v[92:95], a[236:239], v[172:175], v[92:95]
    ds_write2st64_b32 v1, v98, v99 offset0:46 offset1:47
    s_waitcnt vmcnt(10)
    v_mfma_f32_16x16x32_bf16 v[96:99], a[112:115], v[144:147], 0
    buffer_load_dwordx2 v[28:29], v8, s[28:31], s57 offen offset:2048
    v_cvt_pk_bf16_f32 v80, v80, v84
    v_perm_b32 v176, v18, v16, s62
    v_mfma_f32_16x16x32_bf16 v[96:99], a[116:119], v[148:151], v[96:99]
    v_cvt_pk_bf16_f32 v81, v81, v85
    v_perm_b32 v177, v22, v20, s62
    v_mfma_f32_16x16x32_bf16 v[96:99], a[240:243], v[152:155], v[96:99]
    ds_write_b64 v11, v[176:177] offset:0
    v_mfma_f32_16x16x32_bf16 v[96:99], a[244:247], v[156:159], v[96:99]
    ds_write2st64_b32 v1, v80, v81 offset0:48 offset1:49
    v_perm_b32 v178, v18, v16, s63
    v_perm_b32 v179, v22, v20, s63
    v_mfma_f32_16x16x32_bf16 v[100:103], a[112:115], v[160:163], 0
    v_cvt_pk_bf16_f32 v82, v82, v86
    ds_write_b64 v11, v[178:179] offset:1024
    v_mfma_f32_16x16x32_bf16 v[100:103], a[116:119], v[164:167], v[100:103]
    v_cvt_pk_bf16_f32 v83, v83, v87
    v_perm_b32 v180, v19, v17, s62
    v_mfma_f32_16x16x32_bf16 v[100:103], a[240:243], v[168:171], v[100:103]
    v_perm_b32 v181, v23, v21, s62
    v_mfma_f32_16x16x32_bf16 v[100:103], a[244:247], v[172:175], v[100:103]
    ds_write2st64_b32 v1, v82, v83 offset0:50 offset1:51
    ds_write_b64 v11, v[180:181] offset:16
    v_perm_b32 v182, v19, v17, s63
    v_mfma_f32_16x16x32_bf16 v[80:83], a[120:123], v[144:147], 0
    v_cvt_pk_bf16_f32 v88, v88, v92
    v_perm_b32 v183, v23, v21, s63
    v_mfma_f32_16x16x32_bf16 v[80:83], a[124:127], v[148:151], v[80:83]
    v_cvt_pk_bf16_f32 v89, v89, v93
    ds_write_b64 v11, v[182:183] offset:1040
    v_mfma_f32_16x16x32_bf16 v[80:83], a[248:251], v[152:155], v[80:83]
    v_xor_b32 v11, 0x2000, v11
    v_mfma_f32_16x16x32_bf16 v[80:83], a[252:255], v[156:159], v[80:83]
    ds_write2st64_b32 v1, v88, v89 offset0:52 offset1:53
    v_mfma_f32_16x16x32_bf16 v[84:87], a[120:123], v[160:163], 0
    v_cvt_pk_bf16_f32 v90, v90, v94
    v_mfma_f32_16x16x32_bf16 v[84:87], a[124:127], v[164:167], v[84:87]
    v_cvt_pk_bf16_f32 v91, v91, v95
    v_mfma_f32_16x16x32_bf16 v[84:87], a[248:251], v[168:171], v[84:87]
    v_mfma_f32_16x16x32_bf16 v[84:87], a[252:255], v[172:175], v[84:87]
    ds_write2st64_b32 v1, v90, v91 offset0:54 offset1:55
    v_cvt_pk_bf16_f32 v96, v96, v100
    v_cvt_pk_bf16_f32 v97, v97, v101
    ds_write2st64_b32 v1, v96, v97 offset0:56 offset1:57
    v_cvt_pk_bf16_f32 v98, v98, v102
    v_cvt_pk_bf16_f32 v99, v99, v103
    ds_write2st64_b32 v1, v98, v99 offset0:58 offset1:59
    s_nop 0
    v_cvt_pk_bf16_f32 v80, v80, v84
    v_cvt_pk_bf16_f32 v81, v81, v85
    ds_write2st64_b32 v1, v80, v81 offset0:60 offset1:61
    v_cvt_pk_bf16_f32 v82, v82, v86
    v_cvt_pk_bf16_f32 v83, v83, v87
    ds_write2st64_b32 v1, v82, v83 offset0:62 offset1:63
    v_xor_b32 v1, 0x10000, v1
    s_waitcnt lgkmcnt(0)
    s_barrier
L_stage:
    s_nop 1
    ds_read_b128 v[144:147], v10 offset:0
    ds_read_b128 v[148:151], v10 offset:2048
    ds_read_b128 v[152:155], v10 offset:4096
    ds_read_b128 v[156:159], v10 offset:6144
    ds_read_b128 v[160:163], v10 offset:1024
    ds_read_b128 v[164:167], v10 offset:3072
    ds_read_b128 v[168:171], v10 offset:5120
    ds_read_b128 v[172:175], v10 offset:7168
    v_xor_b32 v10, 0x2000, v10
    s_waitcnt vmcnt(7)
    v_lshlrev_b32_sdwa v64, 3, v32 dst_sel:DWORD dst_unused:UNUSED_PAD src0_sel:DWORD src1_sel:WORD_0
    v_lshlrev_b32_sdwa v65, 3, v32 dst_sel:DWORD dst_unused:UNUSED_PAD src0_sel:DWORD src1_sel:WORD_1
    v_lshlrev_b32_sdwa v66, 3, v33 dst_sel:DWORD dst_unused:UNUSED_PAD src0_sel:DWORD src1_sel:WORD_0
    ds_read_b64 v[104:105], v64
    v_lshlrev_b32_sdwa v67, 3, v33 dst_sel:DWORD dst_unused:UNUSED_PAD src0_sel:DWORD src1_sel:WORD_1
    ds_read_b64 v[106:107], v65
    v_lshlrev_b32_sdwa v68, 3, v34 dst_sel:DWORD dst_unused:UNUSED_PAD src0_sel:DWORD src1_sel:WORD_0
    ds_read_b64 v[108:109], v66
    v_lshlrev_b32_sdwa v69, 3, v34 dst_sel:DWORD dst_unused:UNUSED_PAD src0_sel:DWORD src1_sel:WORD_1
    ds_read_b64 v[110:111], v67
    v_lshlrev_b32_sdwa v70, 3, v35 dst_sel:DWORD dst_unused:UNUSED_PAD src0_sel:DWORD src1_sel:WORD_0
    s_waitcnt vmcnt(6)
    ds_read_b64 v[112:113], v68
    v_lshlrev_b32_sdwa v71, 3, v35 dst_sel:DWORD dst_unused:UNUSED_PAD src0_sel:DWORD src1_sel:WORD_1
    s_waitcnt lgkmcnt(9)
    v_mfma_f32_16x16x32_bf16 v[80:83], a[0:3], v[144:147], 0
    buffer_load_dwordx4 v[32:35], v2, s[8:11], s59 offen offset:0 sc1
    ds_read_b64 v[114:115], v69
    v_lshlrev_b32_sdwa v72, 3, v36 dst_sel:DWORD dst_unused:UNUSED_PAD src0_sel:DWORD src1_sel:WORD_0
    v_mfma_f32_16x16x32_bf16 v[80:83], a[4:7], v[148:151], v[80:83]
    ds_read_b64 v[116:117], v70
    v_lshlrev_b32_sdwa v73, 3, v36 dst_sel:DWORD dst_unused:UNUSED_PAD src0_sel:DWORD src1_sel:WORD_1
    v_mfma_f32_16x16x32_bf16 v[80:83], a[128:131], v[152:155], v[80:83]
    ds_read_b64 v[118:119], v71
    v_lshlrev_b32_sdwa v74, 3, v37 dst_sel:DWORD dst_unused:UNUSED_PAD src0_sel:DWORD src1_sel:WORD_0
    v_mfma_f32_16x16x32_bf16 v[80:83], a[132:135], v[156:159], v[80:83]
    ds_read_b64 v[120:121], v72
    v_lshlrev_b32_sdwa v75, 3, v37 dst_sel:DWORD dst_unused:UNUSED_PAD src0_sel:DWORD src1_sel:WORD_1
    s_waitcnt lgkmcnt(9)
    v_mfma_f32_16x16x32_bf16 v[84:87], a[0:3], v[160:163], 0
    ds_read_b64 v[122:123], v73
    v_lshlrev_b32_sdwa v76, 3, v38 dst_sel:DWORD dst_unused:UNUSED_PAD src0_sel:DWORD src1_sel:WORD_0
    v_mfma_f32_16x16x32_bf16 v[84:87], a[4:7], v[164:167], v[84:87]
    ds_read_b64 v[124:125], v74
    v_lshlrev_b32_sdwa v77, 3, v38 dst_sel:DWORD dst_unused:UNUSED_PAD src0_sel:DWORD src1_sel:WORD_1
    v_mfma_f32_16x16x32_bf16 v[84:87], a[128:131], v[168:171], v[84:87]
    ds_read_b64 v[126:127], v75
    v_lshlrev_b32_sdwa v78, 3, v39 dst_sel:DWORD dst_unused:UNUSED_PAD src0_sel:DWORD src1_sel:WORD_0
    v_mfma_f32_16x16x32_bf16 v[84:87], a[132:135], v[172:175], v[84:87]
    s_waitcnt vmcnt(6)
    s_waitcnt lgkmcnt(8)
    v_smfmac_f32_16x16x64_bf16 v[192:195], v[4:7], v[104:111], v184
    ds_read_b64 v[128:129], v76
    v_lshlrev_b32_sdwa v79, 3, v39 dst_sel:DWORD dst_unused:UNUSED_PAD src0_sel:DWORD src1_sel:WORD_1
    v_mfma_f32_16x16x32_bf16 v[88:91], a[8:11], v[144:147], 0
    buffer_load_dwordx2 v[22:23], v8, s[28:31], s57 offen offset:3072
    s_add_u32 s57, s57, 1048576
    s_cmp_ge_u32 s57, s58
    s_cselect_b32 s57, 0x40000000, s57
    buffer_load_dwordx4 v[36:39], v2, s[8:11], s59 offen offset:1024 sc1
    ds_read_b64 v[130:131], v77
    v_lshlrev_b32_sdwa v64, 3, v40 dst_sel:DWORD dst_unused:UNUSED_PAD src0_sel:DWORD src1_sel:WORD_0
    v_cvt_pk_bf16_f32 v80, v80, v84
    v_mfma_f32_16x16x32_bf16 v[88:91], a[12:15], v[148:151], v[88:91]
    ds_read_b64 v[132:133], v78
    v_lshlrev_b32_sdwa v65, 3, v40 dst_sel:DWORD dst_unused:UNUSED_PAD src0_sel:DWORD src1_sel:WORD_1
    v_cvt_pk_bf16_f32 v81, v81, v85
    v_mfma_f32_16x16x32_bf16 v[88:91], a[136:139], v[152:155], v[88:91]
    ds_read_b64 v[134:135], v79
    v_lshlrev_b32_sdwa v66, 3, v41 dst_sel:DWORD dst_unused:UNUSED_PAD src0_sel:DWORD src1_sel:WORD_0
    v_mfma_f32_16x16x32_bf16 v[88:91], a[140:143], v[156:159], v[88:91]
    ds_write2st64_b32 v1, v80, v81 offset0:0 offset1:1
    s_waitcnt lgkmcnt(9)
    v_smfmac_f32_16x16x64_bf16 v[192:195], v[4:7], v[112:119], v184
    ds_read_b64 v[136:137], v64
    v_lshlrev_b32_sdwa v67, 3, v41 dst_sel:DWORD dst_unused:UNUSED_PAD src0_sel:DWORD src1_sel:WORD_1
    v_mfma_f32_16x16x32_bf16 v[92:95], a[8:11], v[160:163], 0
    ds_read_b64 v[138:139], v65
    v_lshlrev_b32_sdwa v68, 3, v42 dst_sel:DWORD dst_unused:UNUSED_PAD src0_sel:DWORD src1_sel:WORD_0
    v_cvt_pk_bf16_f32 v82, v82, v86
    v_mfma_f32_16x16x32_bf16 v[92:95], a[12:15], v[164:167], v[92:95]
    ds_read_b64 v[140:141], v66
    v_lshlrev_b32_sdwa v69, 3, v42 dst_sel:DWORD dst_unused:UNUSED_PAD src0_sel:DWORD src1_sel:WORD_1
    v_cvt_pk_bf16_f32 v83, v83, v87
    v_mfma_f32_16x16x32_bf16 v[92:95], a[136:139], v[168:171], v[92:95]
    ds_read_b64 v[142:143], v67
    v_lshlrev_b32_sdwa v70, 3, v43 dst_sel:DWORD dst_unused:UNUSED_PAD src0_sel:DWORD src1_sel:WORD_0
    v_mfma_f32_16x16x32_bf16 v[92:95], a[140:143], v[172:175], v[92:95]
    s_waitcnt vmcnt(7)
    ds_write2st64_b32 v1, v82, v83 offset0:2 offset1:3
    s_waitcnt lgkmcnt(10)
    v_smfmac_f32_16x16x64_bf16 v[196:199], v[4:7], v[120:127], v184
    ds_read_b64 v[104:105], v68
    v_lshlrev_b32_sdwa v71, 3, v43 dst_sel:DWORD dst_unused:UNUSED_PAD src0_sel:DWORD src1_sel:WORD_1
    v_mfma_f32_16x16x32_bf16 v[96:99], a[16:19], v[144:147], 0
    buffer_load_dwordx4 v[40:43], v2, s[8:11], s59 offen offset:2048 sc1
    ds_read_b64 v[106:107], v69
    v_lshlrev_b32_sdwa v72, 3, v44 dst_sel:DWORD dst_unused:UNUSED_PAD src0_sel:DWORD src1_sel:WORD_0
    v_cvt_pk_bf16_f32 v88, v88, v92
    v_mfma_f32_16x16x32_bf16 v[96:99], a[20:23], v[148:151], v[96:99]
    ds_read_b64 v[108:109], v70
    v_lshlrev_b32_sdwa v73, 3, v44 dst_sel:DWORD dst_unused:UNUSED_PAD src0_sel:DWORD src1_sel:WORD_1
    v_cvt_pk_bf16_f32 v89, v89, v93
    v_mfma_f32_16x16x32_bf16 v[96:99], a[144:147], v[152:155], v[96:99]
    ds_read_b64 v[110:111], v71
    v_lshlrev_b32_sdwa v74, 3, v45 dst_sel:DWORD dst_unused:UNUSED_PAD src0_sel:DWORD src1_sel:WORD_0
    v_mfma_f32_16x16x32_bf16 v[96:99], a[148:151], v[156:159], v[96:99]
    ds_write2st64_b32 v1, v88, v89 offset0:4 offset1:5
    s_waitcnt lgkmcnt(11)
    v_smfmac_f32_16x16x64_bf16 v[196:199], v[4:7], v[128:135], v184
    ds_read_b64 v[112:113], v72
    v_lshlrev_b32_sdwa v75, 3, v45 dst_sel:DWORD dst_unused:UNUSED_PAD src0_sel:DWORD src1_sel:WORD_1
    v_mfma_f32_16x16x32_bf16 v[100:103], a[16:19], v[160:163], 0
    ds_read_b64 v[114:115], v73
    v_lshlrev_b32_sdwa v76, 3, v46 dst_sel:DWORD dst_unused:UNUSED_PAD src0_sel:DWORD src1_sel:WORD_0
    v_cvt_pk_bf16_f32 v90, v90, v94
    v_mfma_f32_16x16x32_bf16 v[100:103], a[20:23], v[164:167], v[100:103]
    ds_read_b64 v[116:117], v74
    v_lshlrev_b32_sdwa v77, 3, v46 dst_sel:DWORD dst_unused:UNUSED_PAD src0_sel:DWORD src1_sel:WORD_1
    v_cvt_pk_bf16_f32 v91, v91, v95
    v_mfma_f32_16x16x32_bf16 v[100:103], a[144:147], v[168:171], v[100:103]
    ds_read_b64 v[118:119], v75
    v_lshlrev_b32_sdwa v78, 3, v47 dst_sel:DWORD dst_unused:UNUSED_PAD src0_sel:DWORD src1_sel:WORD_0
    v_mfma_f32_16x16x32_bf16 v[100:103], a[148:151], v[172:175], v[100:103]
    s_waitcnt vmcnt(7)
    ds_write2st64_b32 v1, v90, v91 offset0:6 offset1:7
    s_waitcnt lgkmcnt(11)
    v_smfmac_f32_16x16x64_bf16 v[200:203], v[4:7], v[136:143], v184
    ds_read_b64 v[120:121], v76
    v_lshlrev_b32_sdwa v79, 3, v47 dst_sel:DWORD dst_unused:UNUSED_PAD src0_sel:DWORD src1_sel:WORD_1
    v_mfma_f32_16x16x32_bf16 v[80:83], a[24:27], v[144:147], 0
    buffer_load_dwordx4 v[44:47], v2, s[8:11], s59 offen offset:3072 sc1
    s_add_u32 s59, s59, 4096
    ds_read_b64 v[122:123], v77
    v_lshlrev_b32_sdwa v64, 3, v48 dst_sel:DWORD dst_unused:UNUSED_PAD src0_sel:DWORD src1_sel:WORD_0
    v_cvt_pk_bf16_f32 v96, v96, v100
    v_mfma_f32_16x16x32_bf16 v[80:83], a[28:31], v[148:151], v[80:83]
    ds_read_b64 v[124:125], v78
    v_lshlrev_b32_sdwa v65, 3, v48 dst_sel:DWORD dst_unused:UNUSED_PAD src0_sel:DWORD src1_sel:WORD_1
    v_cvt_pk_bf16_f32 v97, v97, v101
    v_mfma_f32_16x16x32_bf16 v[80:83], a[152:155], v[152:155], v[80:83]
    ds_read_b64 v[126:127], v79
    v_lshlrev_b32_sdwa v66, 3, v49 dst_sel:DWORD dst_unused:UNUSED_PAD src0_sel:DWORD src1_sel:WORD_0
    v_mfma_f32_16x16x32_bf16 v[80:83], a[156:159], v[156:159], v[80:83]
    ds_write2st64_b32 v1, v96, v97 offset0:8 offset1:9
    s_waitcnt lgkmcnt(11)
    v_smfmac_f32_16x16x64_bf16 v[200:203], v[4:7], v[104:111], v184
    ds_read_b64 v[128:129], v64
    v_lshlrev_b32_sdwa v67, 3, v49 dst_sel:DWORD dst_unused:UNUSED_PAD src0_sel:DWORD src1_sel:WORD_1
    v_mfma_f32_16x16x32_bf16 v[84:87], a[24:27], v[160:163], 0
    ds_read_b64 v[130:131], v65
    v_lshlrev_b32_sdwa v68, 3, v50 dst_sel:DWORD dst_unused:UNUSED_PAD src0_sel:DWORD src1_sel:WORD_0
    v_cvt_pk_bf16_f32 v98, v98, v102
    v_mfma_f32_16x16x32_bf16 v[84:87], a[28:31], v[164:167], v[84:87]
    ds_read_b64 v[132:133], v66
    v_lshlrev_b32_sdwa v69, 3, v50 dst_sel:DWORD dst_unused:UNUSED_PAD src0_sel:DWORD src1_sel:WORD_1
    v_cvt_pk_bf16_f32 v99, v99, v103
    v_mfma_f32_16x16x32_bf16 v[84:87], a[152:155], v[168:171], v[84:87]
    ds_read_b64 v[134:135], v67
    v_lshlrev_b32_sdwa v70, 3, v51 dst_sel:DWORD dst_unused:UNUSED_PAD src0_sel:DWORD src1_sel:WORD_0
    v_mfma_f32_16x16x32_bf16 v[84:87], a[156:159], v[172:175], v[84:87]
    s_waitcnt vmcnt(7)
    ds_write2st64_b32 v1, v98, v99 offset0:10 offset1:11
    s_waitcnt lgkmcnt(11)
    v_smfmac_f32_16x16x64_bf16 v[204:207], v[4:7], v[112:119], v184
    ds_read_b64 v[136:137], v68
    v_lshlrev_b32_sdwa v71, 3, v51 dst_sel:DWORD dst_unused:UNUSED_PAD src0_sel:DWORD src1_sel:WORD_1
    v_mfma_f32_16x16x32_bf16 v[88:91], a[32:35], v[144:147], 0
    s_waitcnt vmcnt(5)
    v_mov_b32 v16, v24
    v_mov_b32 v17, v25
    v_mov_b32 v18, v26
    v_mov_b32 v19, v27
    v_mov_b32 v20, v28
    v_mov_b32 v21, v29
    buffer_load_dwordx4 v[48:51], v2, s[8:11], s59 offen offset:0 sc1
    ds_read_b64 v[138:139], v69
    v_lshlrev_b32_sdwa v72, 3, v52 dst_sel:DWORD dst_unused:UNUSED_PAD src0_sel:DWORD src1_sel:WORD_0
    v_cvt_pk_bf16_f32 v80, v80, v84
    v_mfma_f32_16x16x32_bf16 v[88:91], a[36:39], v[148:151], v[88:91]
    ds_read_b64 v[140:141], v70
    v_lshlrev_b32_sdwa v73, 3, v52 dst_sel:DWORD dst_unused:UNUSED_PAD src0_sel:DWORD src1_sel:WORD_1
    v_cvt_pk_bf16_f32 v81, v81, v85
    v_mfma_f32_16x16x32_bf16 v[88:91], a[160:163], v[152:155], v[88:91]
    ds_read_b64 v[142:143], v71
    v_lshlrev_b32_sdwa v74, 3, v53 dst_sel:DWORD dst_unused:UNUSED_PAD src0_sel:DWORD src1_sel:WORD_0
    v_mfma_f32_16x16x32_bf16 v[88:91], a[164:167], v[156:159], v[88:91]
    ds_write2st64_b32 v1, v80, v81 offset0:12 offset1:13
    s_waitcnt lgkmcnt(11)
    v_smfmac_f32_16x16x64_bf16 v[204:207], v[4:7], v[120:127], v184
    ds_read_b64 v[104:105], v72
    v_lshlrev_b32_sdwa v75, 3, v53 dst_sel:DWORD dst_unused:UNUSED_PAD src0_sel:DWORD src1_sel:WORD_1
    v_mfma_f32_16x16x32_bf16 v[92:95], a[32:35], v[160:163], 0
    ds_read_b64 v[106:107], v73
    v_lshlrev_b32_sdwa v76, 3, v54 dst_sel:DWORD dst_unused:UNUSED_PAD src0_sel:DWORD src1_sel:WORD_0
    v_cvt_pk_bf16_f32 v82, v82, v86
    v_mfma_f32_16x16x32_bf16 v[92:95], a[36:39], v[164:167], v[92:95]
    ds_read_b64 v[108:109], v74
    v_lshlrev_b32_sdwa v77, 3, v54 dst_sel:DWORD dst_unused:UNUSED_PAD src0_sel:DWORD src1_sel:WORD_1
    v_cvt_pk_bf16_f32 v83, v83, v87
    v_mfma_f32_16x16x32_bf16 v[92:95], a[160:163], v[168:171], v[92:95]
    ds_read_b64 v[110:111], v75
    v_lshlrev_b32_sdwa v78, 3, v55 dst_sel:DWORD dst_unused:UNUSED_PAD src0_sel:DWORD src1_sel:WORD_0
    v_mfma_f32_16x16x32_bf16 v[92:95], a[164:167], v[172:175], v[92:95]
    ds_write2st64_b32 v1, v82, v83 offset0:14 offset1:15
    s_waitcnt lgkmcnt(11)
    v_smfmac_f32_16x16x64_bf16 v[208:211], v[4:7], v[128:135], v184
    ds_read_b64 v[112:113], v76
    v_lshlrev_b32_sdwa v79, 3, v55 dst_sel:DWORD dst_unused:UNUSED_PAD src0_sel:DWORD src1_sel:WORD_1
    v_mfma_f32_16x16x32_bf16 v[96:99], a[40:43], v[144:147], 0
    buffer_load_dwordx2 v[24:25], v8, s[28:31], s57 offen offset:0
    buffer_load_dwordx4 v[52:55], v2, s[8:11], s59 offen offset:1024 sc1
    ds_read_b64 v[114:115], v77
    v_lshlrev_b32_sdwa v64, 3, v56 dst_sel:DWORD dst_unused:UNUSED_PAD src0_sel:DWORD src1_sel:WORD_0
    v_cvt_pk_bf16_f32 v88, v88, v92
    v_mfma_f32_16x16x32_bf16 v[96:99], a[44:47], v[148:151], v[96:99]
    ds_read_b64 v[116:117], v78
    v_lshlrev_b32_sdwa v65, 3, v56 dst_sel:DWORD dst_unused:UNUSED_PAD src0_sel:DWORD src1_sel:WORD_1
    v_cvt_pk_bf16_f32 v89, v89, v93
    v_mfma_f32_16x16x32_bf16 v[96:99], a[168:171], v[152:155], v[96:99]
    ds_read_b64 v[118:119], v79
    v_lshlrev_b32_sdwa v66, 3, v57 dst_sel:DWORD dst_unused:UNUSED_PAD src0_sel:DWORD src1_sel:WORD_0
    v_mfma_f32_16x16x32_bf16 v[96:99], a[172:175], v[156:159], v[96:99]
    ds_write2st64_b32 v1, v88, v89 offset0:16 offset1:17
    s_waitcnt lgkmcnt(11)
    v_smfmac_f32_16x16x64_bf16 v[208:211], v[4:7], v[136:143], v184
    ds_read_b64 v[120:121], v64
    v_lshlrev_b32_sdwa v67, 3, v57 dst_sel:DWORD dst_unused:UNUSED_PAD src0_sel:DWORD src1_sel:WORD_1
    v_mfma_f32_16x16x32_bf16 v[100:103], a[40:43], v[160:163], 0
    ds_read_b64 v[122:123], v65
    v_lshlrev_b32_sdwa v68, 3, v58 dst_sel:DWORD dst_unused:UNUSED_PAD src0_sel:DWORD src1_sel:WORD_0
    v_cvt_pk_bf16_f32 v90, v90, v94
    v_mfma_f32_16x16x32_bf16 v[100:103], a[44:47], v[164:167], v[100:103]
    ds_read_b64 v[124:125], v66
    v_lshlrev_b32_sdwa v69, 3, v58 dst_sel:DWORD dst_unused:UNUSED_PAD src0_sel:DWORD src1_sel:WORD_1
    v_cvt_pk_bf16_f32 v91, v91, v95
    v_mfma_f32_16x16x32_bf16 v[100:103], a[168:171], v[168:171], v[100:103]
    ds_read_b64 v[126:127], v67
    v_lshlrev_b32_sdwa v70, 3, v59 dst_sel:DWORD dst_unused:UNUSED_PAD src0_sel:DWORD src1_sel:WORD_0
    v_mfma_f32_16x16x32_bf16 v[100:103], a[172:175], v[172:175], v[100:103]
    ds_write2st64_b32 v1, v90, v91 offset0:18 offset1:19
    s_waitcnt lgkmcnt(11)
    v_smfmac_f32_16x16x64_bf16 v[212:215], v[4:7], v[104:111], v184
    ds_read_b64 v[128:129], v68
    v_lshlrev_b32_sdwa v71, 3, v59 dst_sel:DWORD dst_unused:UNUSED_PAD src0_sel:DWORD src1_sel:WORD_1
    v_mfma_f32_16x16x32_bf16 v[80:83], a[48:51], v[144:147], 0
    buffer_load_dword v14, v3, s[28:31], s3 offen
    s_add_u32 s3, s3, 16384
    s_cmp_eq_u32 s56, 0
    s_cselect_b32 s3, s3, 0x40000000
    buffer_load_dwordx4 v[56:59], v2, s[8:11], s59 offen offset:2048 sc1
    ds_read_b64 v[130:131], v69
    v_lshlrev_b32_sdwa v72, 3, v60 dst_sel:DWORD dst_unused:UNUSED_PAD src0_sel:DWORD src1_sel:WORD_0
    v_cvt_pk_bf16_f32 v96, v96, v100
    v_mfma_f32_16x16x32_bf16 v[80:83], a[52:55], v[148:151], v[80:83]
    ds_read_b64 v[132:133], v70
    v_lshlrev_b32_sdwa v73, 3, v60 dst_sel:DWORD dst_unused:UNUSED_PAD src0_sel:DWORD src1_sel:WORD_1
    v_cvt_pk_bf16_f32 v97, v97, v101
    v_mfma_f32_16x16x32_bf16 v[80:83], a[176:179], v[152:155], v[80:83]
    ds_read_b64 v[134:135], v71
    v_lshlrev_b32_sdwa v74, 3, v61 dst_sel:DWORD dst_unused:UNUSED_PAD src0_sel:DWORD src1_sel:WORD_0
    v_mfma_f32_16x16x32_bf16 v[80:83], a[180:183], v[156:159], v[80:83]
    ds_write2st64_b32 v1, v96, v97 offset0:20 offset1:21
    s_waitcnt lgkmcnt(11)
    v_smfmac_f32_16x16x64_bf16 v[212:215], v[4:7], v[112:119], v184
    ds_read_b64 v[136:137], v72
    v_lshlrev_b32_sdwa v75, 3, v61 dst_sel:DWORD dst_unused:UNUSED_PAD src0_sel:DWORD src1_sel:WORD_1
    v_mfma_f32_16x16x32_bf16 v[84:87], a[48:51], v[160:163], 0
    ds_read_b64 v[138:139], v73
    v_lshlrev_b32_sdwa v76, 3, v62 dst_sel:DWORD dst_unused:UNUSED_PAD src0_sel:DWORD src1_sel:WORD_0
    v_cvt_pk_bf16_f32 v98, v98, v102
    v_mfma_f32_16x16x32_bf16 v[84:87], a[52:55], v[164:167], v[84:87]
    ds_read_b64 v[140:141], v74
    v_lshlrev_b32_sdwa v77, 3, v62 dst_sel:DWORD dst_unused:UNUSED_PAD src0_sel:DWORD src1_sel:WORD_1
    v_cvt_pk_bf16_f32 v99, v99, v103
    v_mfma_f32_16x16x32_bf16 v[84:87], a[176:179], v[168:171], v[84:87]
    ds_read_b64 v[142:143], v75
    v_lshlrev_b32_sdwa v78, 3, v63 dst_sel:DWORD dst_unused:UNUSED_PAD src0_sel:DWORD src1_sel:WORD_0
    v_mfma_f32_16x16x32_bf16 v[84:87], a[180:183], v[172:175], v[84:87]
    s_waitcnt vmcnt(9)
    ds_write2st64_b32 v1, v98, v99 offset0:22 offset1:23
    s_waitcnt lgkmcnt(11)
    v_smfmac_f32_16x16x64_bf16 v[216:219], v[4:7], v[120:127], v184
    ds_read_b64 v[104:105], v76
    v_lshlrev_b32_sdwa v79, 3, v63 dst_sel:DWORD dst_unused:UNUSED_PAD src0_sel:DWORD src1_sel:WORD_1
    v_mfma_f32_16x16x32_bf16 v[88:91], a[56:59], v[144:147], 0
    buffer_load_dwordx4 v[60:63], v2, s[8:11], s59 offen offset:3072 sc1
    s_add_u32 s59, s59, 4096
    ds_read_b64 v[106:107], v77
    v_lshlrev_b32_sdwa v64, 3, v32 dst_sel:DWORD dst_unused:UNUSED_PAD src0_sel:DWORD src1_sel:WORD_0
    v_cvt_pk_bf16_f32 v80, v80, v84
    v_mfma_f32_16x16x32_bf16 v[88:91], a[60:63], v[148:151], v[88:91]
    ds_read_b64 v[108:109], v78
    v_lshlrev_b32_sdwa v65, 3, v32 dst_sel:DWORD dst_unused:UNUSED_PAD src0_sel:DWORD src1_sel:WORD_1
    v_cvt_pk_bf16_f32 v81, v81, v85
    v_mfma_f32_16x16x32_bf16 v[88:91], a[184:187], v[152:155], v[88:91]
    ds_read_b64 v[110:111], v79
    v_lshlrev_b32_sdwa v66, 3, v33 dst_sel:DWORD dst_unused:UNUSED_PAD src0_sel:DWORD src1_sel:WORD_0
    v_mfma_f32_16x16x32_bf16 v[88:91], a[188:191], v[156:159], v[88:91]
    ds_write2st64_b32 v1, v80, v81 offset0:24 offset1:25
    s_waitcnt lgkmcnt(11)
    v_smfmac_f32_16x16x64_bf16 v[216:219], v[4:7], v[128:135], v184
    ds_read_b64 v[112:113], v64
    v_lshlrev_b32_sdwa v67, 3, v33 dst_sel:DWORD dst_unused:UNUSED_PAD src0_sel:DWORD src1_sel:WORD_1
    v_mfma_f32_16x16x32_bf16 v[92:95], a[56:59], v[160:163], 0
    ds_read_b64 v[114:115], v65
    v_lshlrev_b32_sdwa v68, 3, v34 dst_sel:DWORD dst_unused:UNUSED_PAD src0_sel:DWORD src1_sel:WORD_0
    v_cvt_pk_bf16_f32 v82, v82, v86
    v_mfma_f32_16x16x32_bf16 v[92:95], a[60:63], v[164:167], v[92:95]
    ds_read_b64 v[116:117], v66
    v_lshlrev_b32_sdwa v69, 3, v34 dst_sel:DWORD dst_unused:UNUSED_PAD src0_sel:DWORD src1_sel:WORD_1
    v_cvt_pk_bf16_f32 v83, v83, v87
    v_mfma_f32_16x16x32_bf16 v[92:95], a[184:187], v[168:171], v[92:95]
    ds_read_b64 v[118:119], v67
    v_lshlrev_b32_sdwa v70, 3, v35 dst_sel:DWORD dst_unused:UNUSED_PAD src0_sel:DWORD src1_sel:WORD_0
    v_mfma_f32_16x16x32_bf16 v[92:95], a[188:191], v[172:175], v[92:95]
    s_waitcnt vmcnt(8)
    ds_write2st64_b32 v1, v82, v83 offset0:26 offset1:27
    s_waitcnt lgkmcnt(11)
    v_smfmac_f32_16x16x64_bf16 v[220:223], v[4:7], v[136:143], v184
    ds_read_b64 v[120:121], v68
    v_lshlrev_b32_sdwa v71, 3, v35 dst_sel:DWORD dst_unused:UNUSED_PAD src0_sel:DWORD src1_sel:WORD_1
    v_mfma_f32_16x16x32_bf16 v[96:99], a[64:67], v[144:147], 0
    buffer_load_dwordx4 v[32:35], v2, s[8:11], s59 offen offset:0 sc1
    ds_read_b64 v[122:123], v69
    v_lshlrev_b32_sdwa v72, 3, v36 dst_sel:DWORD dst_unused:UNUSED_PAD src0_sel:DWORD src1_sel:WORD_0
    v_cvt_pk_bf16_f32 v88, v88, v92
    v_mfma_f32_16x16x32_bf16 v[96:99], a[68:71], v[148:151], v[96:99]
    ds_read_b64 v[124:125], v70
    v_lshlrev_b32_sdwa v73, 3, v36 dst_sel:DWORD dst_unused:UNUSED_PAD src0_sel:DWORD src1_sel:WORD_1
    v_cvt_pk_bf16_f32 v89, v89, v93
    v_mfma_f32_16x16x32_bf16 v[96:99], a[192:195], v[152:155], v[96:99]
    ds_read_b64 v[126:127], v71
    v_lshlrev_b32_sdwa v74, 3, v37 dst_sel:DWORD dst_unused:UNUSED_PAD src0_sel:DWORD src1_sel:WORD_0
    v_mfma_f32_16x16x32_bf16 v[96:99], a[196:199], v[156:159], v[96:99]
    ds_write2st64_b32 v1, v88, v89 offset0:28 offset1:29
    s_waitcnt lgkmcnt(11)
    v_smfmac_f32_16x16x64_bf16 v[220:223], v[4:7], v[104:111], v184
    ds_read_b64 v[128:129], v72
    v_lshlrev_b32_sdwa v75, 3, v37 dst_sel:DWORD dst_unused:UNUSED_PAD src0_sel:DWORD src1_sel:WORD_1
    v_mfma_f32_16x16x32_bf16 v[100:103], a[64:67], v[160:163], 0
    ds_read_b64 v[130:131], v73
    v_lshlrev_b32_sdwa v76, 3, v38 dst_sel:DWORD dst_unused:UNUSED_PAD src0_sel:DWORD src1_sel:WORD_0
    v_cvt_pk_bf16_f32 v90, v90, v94
    v_mfma_f32_16x16x32_bf16 v[100:103], a[68:71], v[164:167], v[100:103]
    ds_read_b64 v[132:133], v74
    v_lshlrev_b32_sdwa v77, 3, v38 dst_sel:DWORD dst_unused:UNUSED_PAD src0_sel:DWORD src1_sel:WORD_1
    v_cvt_pk_bf16_f32 v91, v91, v95
    v_mfma_f32_16x16x32_bf16 v[100:103], a[192:195], v[168:171], v[100:103]
    ds_read_b64 v[134:135], v75
    v_lshlrev_b32_sdwa v78, 3, v39 dst_sel:DWORD dst_unused:UNUSED_PAD src0_sel:DWORD src1_sel:WORD_0
    v_mfma_f32_16x16x32_bf16 v[100:103], a[196:199], v[172:175], v[100:103]
    s_waitcnt vmcnt(8)
    ds_write2st64_b32 v1, v90, v91 offset0:30 offset1:31
    s_waitcnt lgkmcnt(11)
    v_smfmac_f32_16x16x64_bf16 v[224:227], v[4:7], v[112:119], v184
    ds_read_b64 v[136:137], v76
    v_lshlrev_b32_sdwa v79, 3, v39 dst_sel:DWORD dst_unused:UNUSED_PAD src0_sel:DWORD src1_sel:WORD_1
    v_mfma_f32_16x16x32_bf16 v[80:83], a[72:75], v[144:147], 0
    buffer_load_dwordx2 v[26:27], v8, s[28:31], s57 offen offset:1024
    buffer_load_dwordx4 v[36:39], v2, s[8:11], s59 offen offset:1024 sc1
    ds_read_b64 v[138:139], v77
    v_lshlrev_b32_sdwa v64, 3, v40 dst_sel:DWORD dst_unused:UNUSED_PAD src0_sel:DWORD src1_sel:WORD_0
    v_cvt_pk_bf16_f32 v96, v96, v100
    v_mfma_f32_16x16x32_bf16 v[80:83], a[76:79], v[148:151], v[80:83]
    ds_read_b64 v[140:141], v78
    v_lshlrev_b32_sdwa v65, 3, v40 dst_sel:DWORD dst_unused:UNUSED_PAD src0_sel:DWORD src1_sel:WORD_1
    v_cvt_pk_bf16_f32 v97, v97, v101
    v_mfma_f32_16x16x32_bf16 v[80:83], a[200:203], v[152:155], v[80:83]
    ds_read_b64 v[142:143], v79
    v_lshlrev_b32_sdwa v66, 3, v41 dst_sel:DWORD dst_unused:UNUSED_PAD src0_sel:DWORD src1_sel:WORD_0
    v_mfma_f32_16x16x32_bf16 v[80:83], a[204:207], v[156:159], v[80:83]
    ds_write2st64_b32 v1, v96, v97 offset0:32 offset1:33
    s_waitcnt lgkmcnt(11)
    v_smfmac_f32_16x16x64_bf16 v[224:227], v[4:7], v[120:127], v184
    ds_read_b64 v[104:105], v64
    v_lshlrev_b32_sdwa v67, 3, v41 dst_sel:DWORD dst_unused:UNUSED_PAD src0_sel:DWORD src1_sel:WORD_1
    v_mfma_f32_16x16x32_bf16 v[84:87], a[72:75], v[160:163], 0
    ds_read_b64 v[106:107], v65
    v_lshlrev_b32_sdwa v68, 3, v42 dst_sel:DWORD dst_unused:UNUSED_PAD src0_sel:DWORD src1_sel:WORD_0
    v_cvt_pk_bf16_f32 v98, v98, v102
    v_mfma_f32_16x16x32_bf16 v[84:87], a[76:79], v[164:167], v[84:87]
    ds_read_b64 v[108:109], v66
    v_lshlrev_b32_sdwa v69, 3, v42 dst_sel:DWORD dst_unused:UNUSED_PAD src0_sel:DWORD src1_sel:WORD_1
    v_cvt_pk_bf16_f32 v99, v99, v103
    v_mfma_f32_16x16x32_bf16 v[84:87], a[200:203], v[168:171], v[84:87]
    ds_read_b64 v[110:111], v67
    v_lshlrev_b32_sdwa v70, 3, v43 dst_sel:DWORD dst_unused:UNUSED_PAD src0_sel:DWORD src1_sel:WORD_0
    v_mfma_f32_16x16x32_bf16 v[84:87], a[204:207], v[172:175], v[84:87]
    s_waitcnt vmcnt(9)
    ds_write2st64_b32 v1, v98, v99 offset0:34 offset1:35
    s_waitcnt lgkmcnt(11)
    v_smfmac_f32_16x16x64_bf16 v[228:231], v[4:7], v[128:135], v184
    ds_read_b64 v[112:113], v68
    v_lshlrev_b32_sdwa v71, 3, v43 dst_sel:DWORD dst_unused:UNUSED_PAD src0_sel:DWORD src1_sel:WORD_1
    v_mfma_f32_16x16x32_bf16 v[88:91], a[80:83], v[144:147], 0
    buffer_load_dwordx4 v[40:43], v2, s[8:11], s59 offen offset:2048 sc1
    ds_read_b64 v[114:115], v69
    v_lshlrev_b32_sdwa v72, 3, v44 dst_sel:DWORD dst_unused:UNUSED_PAD src0_sel:DWORD src1_sel:WORD_0
    v_cvt_pk_bf16_f32 v80, v80, v84
    v_mfma_f32_16x16x32_bf16 v[88:91], a[84:87], v[148:151], v[88:91]
    ds_read_b64 v[116:117], v70
    v_lshlrev_b32_sdwa v73, 3, v44 dst_sel:DWORD dst_unused:UNUSED_PAD src0_sel:DWORD src1_sel:WORD_1
    v_cvt_pk_bf16_f32 v81, v81, v85
    v_mfma_f32_16x16x32_bf16 v[88:91], a[208:211], v[152:155], v[88:91]
    ds_read_b64 v[118:119], v71
    v_lshlrev_b32_sdwa v74, 3, v45 dst_sel:DWORD dst_unused:UNUSED_PAD src0_sel:DWORD src1_sel:WORD_0
    v_mfma_f32_16x16x32_bf16 v[88:91], a[212:215], v[156:159], v[88:91]
    ds_write2st64_b32 v1, v80, v81 offset0:36 offset1:37
    s_waitcnt lgkmcnt(11)
    v_smfmac_f32_16x16x64_bf16 v[228:231], v[4:7], v[136:143], v184
    ds_read_b64 v[120:121], v72
    v_lshlrev_b32_sdwa v75, 3, v45 dst_sel:DWORD dst_unused:UNUSED_PAD src0_sel:DWORD src1_sel:WORD_1
    v_mfma_f32_16x16x32_bf16 v[92:95], a[80:83], v[160:163], 0
    ds_read_b64 v[122:123], v73
    v_lshlrev_b32_sdwa v76, 3, v46 dst_sel:DWORD dst_unused:UNUSED_PAD src0_sel:DWORD src1_sel:WORD_0
    v_cvt_pk_bf16_f32 v82, v82, v86
    v_mfma_f32_16x16x32_bf16 v[92:95], a[84:87], v[164:167], v[92:95]
    ds_read_b64 v[124:125], v74
    v_lshlrev_b32_sdwa v77, 3, v46 dst_sel:DWORD dst_unused:UNUSED_PAD src0_sel:DWORD src1_sel:WORD_1
    v_cvt_pk_bf16_f32 v83, v83, v87
    v_mfma_f32_16x16x32_bf16 v[92:95], a[208:211], v[168:171], v[92:95]
    ds_read_b64 v[126:127], v75
    v_lshlrev_b32_sdwa v78, 3, v47 dst_sel:DWORD dst_unused:UNUSED_PAD src0_sel:DWORD src1_sel:WORD_0
    v_mfma_f32_16x16x32_bf16 v[92:95], a[212:215], v[172:175], v[92:95]
    s_waitcnt vmcnt(9)
    ds_write2st64_b32 v1, v82, v83 offset0:38 offset1:39
    s_waitcnt lgkmcnt(11)
    v_smfmac_f32_16x16x64_bf16 v[232:235], v[4:7], v[104:111], v184
    ds_read_b64 v[128:129], v76
    v_lshlrev_b32_sdwa v79, 3, v47 dst_sel:DWORD dst_unused:UNUSED_PAD src0_sel:DWORD src1_sel:WORD_1
    v_mfma_f32_16x16x32_bf16 v[96:99], a[88:91], v[144:147], 0
    buffer_load_dwordx4 v[44:47], v2, s[8:11], s59 offen offset:3072 sc1
    s_add_u32 s59, s59, 4096
    ds_read_b64 v[130:131], v77
    v_lshlrev_b32_sdwa v64, 3, v48 dst_sel:DWORD dst_unused:UNUSED_PAD src0_sel:DWORD src1_sel:WORD_0
    v_cvt_pk_bf16_f32 v88, v88, v92
    v_mfma_f32_16x16x32_bf16 v[96:99], a[92:95], v[148:151], v[96:99]
    ds_read_b64 v[132:133], v78
    v_lshlrev_b32_sdwa v65, 3, v48 dst_sel:DWORD dst_unused:UNUSED_PAD src0_sel:DWORD src1_sel:WORD_1
    v_cvt_pk_bf16_f32 v89, v89, v93
    v_mfma_f32_16x16x32_bf16 v[96:99], a[216:219], v[152:155], v[96:99]
    ds_read_b64 v[134:135], v79
    v_lshlrev_b32_sdwa v66, 3, v49 dst_sel:DWORD dst_unused:UNUSED_PAD src0_sel:DWORD src1_sel:WORD_0
    v_mfma_f32_16x16x32_bf16 v[96:99], a[220:223], v[156:159], v[96:99]
    ds_write2st64_b32 v1, v88, v89 offset0:40 offset1:41
    s_waitcnt lgkmcnt(11)
    v_smfmac_f32_16x16x64_bf16 v[232:235], v[4:7], v[112:119], v184
    ds_read_b64 v[136:137], v64
    v_lshlrev_b32_sdwa v67, 3, v49 dst_sel:DWORD dst_unused:UNUSED_PAD src0_sel:DWORD src1_sel:WORD_1
    v_mfma_f32_16x16x32_bf16 v[100:103], a[88:91], v[160:163], 0
    ds_read_b64 v[138:139], v65
    v_lshlrev_b32_sdwa v68, 3, v50 dst_sel:DWORD dst_unused:UNUSED_PAD src0_sel:DWORD src1_sel:WORD_0
    v_cvt_pk_bf16_f32 v90, v90, v94
    v_mfma_f32_16x16x32_bf16 v[100:103], a[92:95], v[164:167], v[100:103]
    ds_read_b64 v[140:141], v66
    v_lshlrev_b32_sdwa v69, 3, v50 dst_sel:DWORD dst_unused:UNUSED_PAD src0_sel:DWORD src1_sel:WORD_1
    v_cvt_pk_bf16_f32 v91, v91, v95
    v_mfma_f32_16x16x32_bf16 v[100:103], a[216:219], v[168:171], v[100:103]
    ds_read_b64 v[142:143], v67
    v_lshlrev_b32_sdwa v70, 3, v51 dst_sel:DWORD dst_unused:UNUSED_PAD src0_sel:DWORD src1_sel:WORD_0
    v_mfma_f32_16x16x32_bf16 v[100:103], a[220:223], v[172:175], v[100:103]
    s_waitcnt vmcnt(8)
    ds_write2st64_b32 v1, v90, v91 offset0:42 offset1:43
    s_waitcnt lgkmcnt(11)
    v_smfmac_f32_16x16x64_bf16 v[236:239], v[4:7], v[120:127], v184
    ds_read_b64 v[104:105], v68
    v_lshlrev_b32_sdwa v71, 3, v51 dst_sel:DWORD dst_unused:UNUSED_PAD src0_sel:DWORD src1_sel:WORD_1
    v_mfma_f32_16x16x32_bf16 v[80:83], a[96:99], v[144:147], 0
    buffer_load_dwordx4 v[48:51], v2, s[8:11], s59 offen offset:0 sc1
    ds_read_b64 v[106:107], v69
    v_lshlrev_b32_sdwa v72, 3, v52 dst_sel:DWORD dst_unused:UNUSED_PAD src0_sel:DWORD src1_sel:WORD_0
    v_cvt_pk_bf16_f32 v96, v96, v100
    v_mfma_f32_16x16x32_bf16 v[80:83], a[100:103], v[148:151], v[80:83]
    ds_read_b64 v[108:109], v70
    v_lshlrev_b32_sdwa v73, 3, v52 dst_sel:DWORD dst_unused:UNUSED_PAD src0_sel:DWORD src1_sel:WORD_1
    v_cvt_pk_bf16_f32 v97, v97, v101
    v_mfma_f32_16x16x32_bf16 v[80:83], a[224:227], v[152:155], v[80:83]
    ds_read_b64 v[110:111], v71
    v_lshlrev_b32_sdwa v74, 3, v53 dst_sel:DWORD dst_unused:UNUSED_PAD src0_sel:DWORD src1_sel:WORD_0
    v_mfma_f32_16x16x32_bf16 v[80:83], a[228:231], v[156:159], v[80:83]
    ds_write2st64_b32 v1, v96, v97 offset0:44 offset1:45
    s_waitcnt lgkmcnt(11)
    v_smfmac_f32_16x16x64_bf16 v[236:239], v[4:7], v[128:135], v184
    ds_read_b64 v[112:113], v72
    v_lshlrev_b32_sdwa v75, 3, v53 dst_sel:DWORD dst_unused:UNUSED_PAD src0_sel:DWORD src1_sel:WORD_1
    v_mfma_f32_16x16x32_bf16 v[84:87], a[96:99], v[160:163], 0
    ds_read_b64 v[114:115], v73
    v_lshlrev_b32_sdwa v76, 3, v54 dst_sel:DWORD dst_unused:UNUSED_PAD src0_sel:DWORD src1_sel:WORD_0
    v_cvt_pk_bf16_f32 v98, v98, v102
    v_mfma_f32_16x16x32_bf16 v[84:87], a[100:103], v[164:167], v[84:87]
    ds_read_b64 v[116:117], v74
    v_lshlrev_b32_sdwa v77, 3, v54 dst_sel:DWORD dst_unused:UNUSED_PAD src0_sel:DWORD src1_sel:WORD_1
    v_cvt_pk_bf16_f32 v99, v99, v103
    v_mfma_f32_16x16x32_bf16 v[84:87], a[224:227], v[168:171], v[84:87]
    ds_read_b64 v[118:119], v75
    v_lshlrev_b32_sdwa v78, 3, v55 dst_sel:DWORD dst_unused:UNUSED_PAD src0_sel:DWORD src1_sel:WORD_0
    v_mfma_f32_16x16x32_bf16 v[84:87], a[228:231], v[172:175], v[84:87]
    s_waitcnt vmcnt(7)
    ds_write2st64_b32 v1, v98, v99 offset0:46 offset1:47
    s_waitcnt lgkmcnt(11)
    v_smfmac_f32_16x16x64_bf16 v[240:243], v[4:7], v[136:143], v184
    ds_read_b64 v[120:121], v76
    v_lshlrev_b32_sdwa v79, 3, v55 dst_sel:DWORD dst_unused:UNUSED_PAD src0_sel:DWORD src1_sel:WORD_1
    v_mfma_f32_16x16x32_bf16 v[88:91], a[104:107], v[144:147], 0
    buffer_load_dwordx2 v[28:29], v8, s[28:31], s57 offen offset:2048
    buffer_load_dwordx4 v[52:55], v2, s[8:11], s59 offen offset:1024 sc1
    ds_read_b64 v[122:123], v77
    v_lshlrev_b32_sdwa v64, 3, v56 dst_sel:DWORD dst_unused:UNUSED_PAD src0_sel:DWORD src1_sel:WORD_0
    v_cvt_pk_bf16_f32 v80, v80, v84
    v_mfma_f32_16x16x32_bf16 v[88:91], a[108:111], v[148:151], v[88:91]
    ds_read_b64 v[124:125], v78
    v_lshlrev_b32_sdwa v65, 3, v56 dst_sel:DWORD dst_unused:UNUSED_PAD src0_sel:DWORD src1_sel:WORD_1
    v_cvt_pk_bf16_f32 v81, v81, v85
    v_mfma_f32_16x16x32_bf16 v[88:91], a[232:235], v[152:155], v[88:91]
    ds_read_b64 v[126:127], v79
    v_lshlrev_b32_sdwa v66, 3, v57 dst_sel:DWORD dst_unused:UNUSED_PAD src0_sel:DWORD src1_sel:WORD_0
    v_mfma_f32_16x16x32_bf16 v[88:91], a[236:239], v[156:159], v[88:91]
    ds_write2st64_b32 v1, v80, v81 offset0:48 offset1:49
    s_waitcnt lgkmcnt(11)
    v_smfmac_f32_16x16x64_bf16 v[240:243], v[4:7], v[104:111], v184
    ds_read_b64 v[128:129], v64
    v_lshlrev_b32_sdwa v67, 3, v57 dst_sel:DWORD dst_unused:UNUSED_PAD src0_sel:DWORD src1_sel:WORD_1
    v_mfma_f32_16x16x32_bf16 v[92:95], a[104:107], v[160:163], 0
    ds_read_b64 v[130:131], v65
    v_lshlrev_b32_sdwa v68, 3, v58 dst_sel:DWORD dst_unused:UNUSED_PAD src0_sel:DWORD src1_sel:WORD_0
    v_cvt_pk_bf16_f32 v82, v82, v86
    v_mfma_f32_16x16x32_bf16 v[92:95], a[108:111], v[164:167], v[92:95]
    ds_read_b64 v[132:133], v66
    v_lshlrev_b32_sdwa v69, 3, v58 dst_sel:DWORD dst_unused:UNUSED_PAD src0_sel:DWORD src1_sel:WORD_1
    v_cvt_pk_bf16_f32 v83, v83, v87
    v_mfma_f32_16x16x32_bf16 v[92:95], a[232:235], v[168:171], v[92:95]
    ds_read_b64 v[134:135], v67
    v_lshlrev_b32_sdwa v70, 3, v59 dst_sel:DWORD dst_unused:UNUSED_PAD src0_sel:DWORD src1_sel:WORD_0
    v_mfma_f32_16x16x32_bf16 v[92:95], a[236:239], v[172:175], v[92:95]
    s_waitcnt vmcnt(8)
    ds_write2st64_b32 v1, v82, v83 offset0:50 offset1:51
    s_waitcnt lgkmcnt(11)
    v_smfmac_f32_16x16x64_bf16 v[244:247], v[4:7], v[112:119], v184
    ds_read_b64 v[136:137], v68
    v_lshlrev_b32_sdwa v71, 3, v59 dst_sel:DWORD dst_unused:UNUSED_PAD src0_sel:DWORD src1_sel:WORD_1
    v_mfma_f32_16x16x32_bf16 v[96:99], a[112:115], v[144:147], 0
    buffer_load_dwordx4 v[56:59], v2, s[8:11], s59 offen offset:2048 sc1
    ds_read_b64 v[138:139], v69
    v_lshlrev_b32_sdwa v72, 3, v60 dst_sel:DWORD dst_unused:UNUSED_PAD src0_sel:DWORD src1_sel:WORD_0
    v_cvt_pk_bf16_f32 v88, v88, v92
    v_mfma_f32_16x16x32_bf16 v[96:99], a[116:119], v[148:151], v[96:99]
    ds_read_b64 v[140:141], v70
    v_lshlrev_b32_sdwa v73, 3, v60 dst_sel:DWORD dst_unused:UNUSED_PAD src0_sel:DWORD src1_sel:WORD_1
    v_cvt_pk_bf16_f32 v89, v89, v93
    v_mfma_f32_16x16x32_bf16 v[96:99], a[240:243], v[152:155], v[96:99]
    ds_read_b64 v[142:143], v71
    v_lshlrev_b32_sdwa v74, 3, v61 dst_sel:DWORD dst_unused:UNUSED_PAD src0_sel:DWORD src1_sel:WORD_0
    v_perm_b32 v176, v18, v16, s62
    v_mfma_f32_16x16x32_bf16 v[96:99], a[244:247], v[156:159], v[96:99]
    ds_write2st64_b32 v1, v88, v89 offset0:52 offset1:53
    v_perm_b32 v177, v22, v20, s62
    s_waitcnt lgkmcnt(11)
    v_smfmac_f32_16x16x64_bf16 v[244:247], v[4:7], v[120:127], v184
    ds_read_b64 v[104:105], v72
    v_lshlrev_b32_sdwa v75, 3, v61 dst_sel:DWORD dst_unused:UNUSED_PAD src0_sel:DWORD src1_sel:WORD_1
    ds_write_b64 v11, v[176:177] offset:0
    v_mfma_f32_16x16x32_bf16 v[100:103], a[112:115], v[160:163], 0
    ds_read_b64 v[106:107], v73
    v_lshlrev_b32_sdwa v76, 3, v62 dst_sel:DWORD dst_unused:UNUSED_PAD src0_sel:DWORD src1_sel:WORD_0
    v_cvt_pk_bf16_f32 v90, v90, v94
    v_mfma_f32_16x16x32_bf16 v[100:103], a[116:119], v[164:167], v[100:103]
    ds_read_b64 v[108:109], v74
    v_lshlrev_b32_sdwa v77, 3, v62 dst_sel:DWORD dst_unused:UNUSED_PAD src0_sel:DWORD src1_sel:WORD_1
    v_cvt_pk_bf16_f32 v91, v91, v95
    v_mfma_f32_16x16x32_bf16 v[100:103], a[240:243], v[168:171], v[100:103]
    ds_read_b64 v[110:111], v75
    v_lshlrev_b32_sdwa v78, 3, v63 dst_sel:DWORD dst_unused:UNUSED_PAD src0_sel:DWORD src1_sel:WORD_0
    v_perm_b32 v178, v18, v16, s63
    v_mfma_f32_16x16x32_bf16 v[100:103], a[244:247], v[172:175], v[100:103]
    ds_write2st64_b32 v1, v90, v91 offset0:54 offset1:55
    v_perm_b32 v179, v22, v20, s63
    s_waitcnt lgkmcnt(12)
    v_smfmac_f32_16x16x64_bf16 v[248:251], v[4:7], v[128:135], v184
    ds_read_b64 v[112:113], v76
    v_lshlrev_b32_sdwa v79, 3, v63 dst_sel:DWORD dst_unused:UNUSED_PAD src0_sel:DWORD src1_sel:WORD_1
    ds_write_b64 v11, v[178:179] offset:1024
    v_mfma_f32_16x16x32_bf16 v[80:83], a[120:123], v[144:147], 0
    buffer_load_dwordx4 v[60:63], v2, s[8:11], s59 offen offset:3072 sc1
    s_add_u32 s59, s59, 4096
    ds_read_b64 v[114:115], v77
    v_cvt_pk_bf16_f32 v96, v96, v100
    v_mfma_f32_16x16x32_bf16 v[80:83], a[124:127], v[148:151], v[80:83]
    ds_read_b64 v[116:117], v78
    v_cvt_pk_bf16_f32 v97, v97, v101
    v_mfma_f32_16x16x32_bf16 v[80:83], a[248:251], v[152:155], v[80:83]
    ds_read_b64 v[118:119], v79
    v_perm_b32 v180, v19, v17, s62
    v_mfma_f32_16x16x32_bf16 v[80:83], a[252:255], v[156:159], v[80:83]
    ds_write2st64_b32 v1, v96, v97 offset0:56 offset1:57
    v_perm_b32 v181, v23, v21, s62
    s_waitcnt lgkmcnt(13)
    v_smfmac_f32_16x16x64_bf16 v[248:251], v[4:7], v[136:143], v184
    ds_write_b64 v11, v[180:181] offset:16
    v_mfma_f32_16x16x32_bf16 v[84:87], a[120:123], v[160:163], 0
    v_cvt_pk_bf16_f32 v98, v98, v102
    v_perm_b32 v182, v19, v17, s63
    v_mfma_f32_16x16x32_bf16 v[84:87], a[124:127], v[164:167], v[84:87]
    v_cvt_pk_bf16_f32 v99, v99, v103
    v_perm_b32 v183, v23, v21, s63
    v_mfma_f32_16x16x32_bf16 v[84:87], a[248:251], v[168:171], v[84:87]
    ds_write_b64 v11, v[182:183] offset:1040
    v_mfma_f32_16x16x32_bf16 v[84:87], a[252:255], v[172:175], v[84:87]
    ds_write2st64_b32 v1, v98, v99 offset0:58 offset1:59
    v_xor_b32 v11, 0x2000, v11
    s_waitcnt lgkmcnt(10)
    v_smfmac_f32_16x16x64_bf16 v[252:255], v[4:7], v[104:111], v184
    s_nop 3
    v_cvt_pk_bf16_f32 v80, v80, v84
    v_cvt_pk_bf16_f32 v81, v81, v85
    ds_write2st64_b32 v1, v80, v81 offset0:60 offset1:61
    s_waitcnt lgkmcnt(5)
    v_smfmac_f32_16x16x64_bf16 v[252:255], v[4:7], v[112:119], v184
    v_cvt_pk_bf16_f32 v82, v82, v86
    v_cvt_pk_bf16_f32 v83, v83, v87
    ds_write2st64_b32 v1, v82, v83 offset0:62 offset1:63
    v_xor_b32 v1, 0x10000, v1
    s_waitcnt lgkmcnt(0)
    s_add_u32 s56, s56, 1
    s_cmp_lg_u32 s56, 5
    s_barrier
    s_cbranch_scc1 L_stage
    s_waitcnt vmcnt(2)
    v_lshlrev_b32_sdwa v64, 3, v32 dst_sel:DWORD dst_unused:UNUSED_PAD src0_sel:DWORD src1_sel:WORD_0
    v_lshlrev_b32_sdwa v65, 3, v32 dst_sel:DWORD dst_unused:UNUSED_PAD src0_sel:DWORD src1_sel:WORD_1
    v_lshlrev_b32_sdwa v66, 3, v33 dst_sel:DWORD dst_unused:UNUSED_PAD src0_sel:DWORD src1_sel:WORD_0
    ds_read_b64 v[104:105], v64
    v_lshlrev_b32_sdwa v67, 3, v33 dst_sel:DWORD dst_unused:UNUSED_PAD src0_sel:DWORD src1_sel:WORD_1
    ds_read_b64 v[106:107], v65
    v_lshlrev_b32_sdwa v68, 3, v34 dst_sel:DWORD dst_unused:UNUSED_PAD src0_sel:DWORD src1_sel:WORD_0
    ds_read_b64 v[108:109], v66
    v_lshlrev_b32_sdwa v69, 3, v34 dst_sel:DWORD dst_unused:UNUSED_PAD src0_sel:DWORD src1_sel:WORD_1
    ds_read_b64 v[110:111], v67
    v_lshlrev_b32_sdwa v70, 3, v35 dst_sel:DWORD dst_unused:UNUSED_PAD src0_sel:DWORD src1_sel:WORD_0
    ds_read_b64 v[112:113], v68
    v_lshlrev_b32_sdwa v71, 3, v35 dst_sel:DWORD dst_unused:UNUSED_PAD src0_sel:DWORD src1_sel:WORD_1
    v_and_b32 v17, 15, v0
    v_bfe_u32 v18, v0, 4, 2
    buffer_load_dwordx4 v[32:35], v2, s[8:11], s59 offen offset:0 sc1
    ds_read_b64 v[114:115], v69
    v_lshlrev_b32_sdwa v72, 3, v36 dst_sel:DWORD dst_unused:UNUSED_PAD src0_sel:DWORD src1_sel:WORD_0
    s_lshl_b32 s53, s48, 14
    ds_read_b64 v[116:117], v70
    v_lshlrev_b32_sdwa v73, 3, v36 dst_sel:DWORD dst_unused:UNUSED_PAD src0_sel:DWORD src1_sel:WORD_1
    v_and_b32 v20, 3, v17
    ds_read_b64 v[118:119], v71
    v_lshlrev_b32_sdwa v74, 3, v37 dst_sel:DWORD dst_unused:UNUSED_PAD src0_sel:DWORD src1_sel:WORD_0
    v_lshrrev_b32 v21, 2, v17
    v_lshl_add_u32 v21, v20, 2, v21
    ds_read_b64 v[120:121], v72
    v_lshlrev_b32_sdwa v75, 3, v37 dst_sel:DWORD dst_unused:UNUSED_PAD src0_sel:DWORD src1_sel:WORD_1
    v_xor_b32 v20, v20, v18
    ds_read_b64 v[122:123], v73
    v_lshlrev_b32_sdwa v76, 3, v38 dst_sel:DWORD dst_unused:UNUSED_PAD src0_sel:DWORD src1_sel:WORD_0
    v_lshlrev_b32 v20, 4, v20
    ds_read_b64 v[124:125], v74
    v_lshlrev_b32_sdwa v77, 3, v38 dst_sel:DWORD dst_unused:UNUSED_PAD src0_sel:DWORD src1_sel:WORD_1
    v_lshl_add_u32 v16, v21, 6, v20
    ds_read_b64 v[126:127], v75
    v_lshlrev_b32_sdwa v78, 3, v39 dst_sel:DWORD dst_unused:UNUSED_PAD src0_sel:DWORD src1_sel:WORD_0
    v_add_u32 v16, s53, v16
    ds_write_b128 v16, a[128:131] offset:0
    s_waitcnt lgkmcnt(9)
    v_smfmac_f32_16x16x64_bf16 v[192:195], v[4:7], v[104:111], v184
    ds_read_b64 v[128:129], v76
    v_lshlrev_b32_sdwa v79, 3, v39 dst_sel:DWORD dst_unused:UNUSED_PAD src0_sel:DWORD src1_sel:WORD_1
    s_movk_i32 s53, 200
    buffer_load_dwordx4 v[36:39], v2, s[8:11], s59 offen offset:1024 sc1
    ds_read_b64 v[130:131], v77
    v_lshlrev_b32_sdwa v64, 3, v40 dst_sel:DWORD dst_unused:UNUSED_PAD src0_sel:DWORD src1_sel:WORD_0
    v_mul_lo_u32 v19, v17, s53
    ds_read_b64 v[132:133], v78
    v_lshlrev_b32_sdwa v65, 3, v40 dst_sel:DWORD dst_unused:UNUSED_PAD src0_sel:DWORD src1_sel:WORD_1
    v_lshl_add_u32 v19, v18, 4, v19
    v_add_u32 v19, 131072, v19
    ds_read_b64 v[134:135], v79
    v_lshlrev_b32_sdwa v66, 3, v41 dst_sel:DWORD dst_unused:UNUSED_PAD src0_sel:DWORD src1_sel:WORD_0
    v_lshrrev_b32 v20, 2, v17
    v_mul_lo_u32 v176, v20, s53
    s_waitcnt lgkmcnt(9)
    v_smfmac_f32_16x16x64_bf16 v[192:195], v[4:7], v[112:119], v184
    ds_read_b64 v[136:137], v64
    v_lshlrev_b32_sdwa v67, 3, v41 dst_sel:DWORD dst_unused:UNUSED_PAD src0_sel:DWORD src1_sel:WORD_1
    v_lshl_add_u32 v176, v18, 4, v176
    ds_read_b64 v[138:139], v65
    v_lshlrev_b32_sdwa v68, 3, v42 dst_sel:DWORD dst_unused:UNUSED_PAD src0_sel:DWORD src1_sel:WORD_0
    v_add_u32 v176, 131072, v176
    ds_read_b64 v[140:141], v66
    v_lshlrev_b32_sdwa v69, 3, v42 dst_sel:DWORD dst_unused:UNUSED_PAD src0_sel:DWORD src1_sel:WORD_1
    v_mov_b32 v172, 0
    ds_read_b64 v[142:143], v67
    v_lshlrev_b32_sdwa v70, 3, v43 dst_sel:DWORD dst_unused:UNUSED_PAD src0_sel:DWORD src1_sel:WORD_0
    v_mov_b32 v173, 0
    ds_write_b128 v16, a[136:139] offset:1024
    s_waitcnt lgkmcnt(10)
    v_smfmac_f32_16x16x64_bf16 v[196:199], v[4:7], v[120:127], v184
    ds_read_b64 v[104:105], v68
    v_lshlrev_b32_sdwa v71, 3, v43 dst_sel:DWORD dst_unused:UNUSED_PAD src0_sel:DWORD src1_sel:WORD_1
    v_mov_b32 v174, 0
    buffer_load_dwordx4 v[40:43], v2, s[8:11], s59 offen offset:2048 sc1
    ds_read_b64 v[106:107], v69
    v_lshlrev_b32_sdwa v72, 3, v44 dst_sel:DWORD dst_unused:UNUSED_PAD src0_sel:DWORD src1_sel:WORD_0
    v_mov_b32 v175, 0
    ds_read_b64 v[108:109], v70
    v_lshlrev_b32_sdwa v73, 3, v44 dst_sel:DWORD dst_unused:UNUSED_PAD src0_sel:DWORD src1_sel:WORD_1
    s_movk_i32 s53, 0x3f80
    v_writelane_b32 v172, s53, 0
    v_writelane_b32 v173, s53, 8
    s_mov_b32 s53, 0x3f800000
    v_writelane_b32 v172, s53, 4
    v_writelane_b32 v173, s53, 12
    ds_read_b64 v[110:111], v71
    v_lshlrev_b32_sdwa v74, 3, v45 dst_sel:DWORD dst_unused:UNUSED_PAD src0_sel:DWORD src1_sel:WORD_0
    v_and_b32 v20, 1, v17
    v_lshlrev_b32 v20, 4, v20
    s_waitcnt lgkmcnt(9)
    v_smfmac_f32_16x16x64_bf16 v[196:199], v[4:7], v[128:135], v184
    buffer_store_dwordx4 v[192:195], v2, s[32:35], s64 offen offset:0 sc1
    s_mul_i32 s51, s48, 6144
    s_add_u32 s51, s51, 0
    s_add_u32 m0, s51, 131072
    s_nop 0
    buffer_load_dwordx4 v2, s[40:43], s51 offen lds
    ds_read_b64 v[112:113], v72
    v_lshlrev_b32_sdwa v75, 3, v45 dst_sel:DWORD dst_unused:UNUSED_PAD src0_sel:DWORD src1_sel:WORD_1
    v_mov_b32 v21, 0x3f80
    v_lshlrev_b32 v21, v20, v21
    ds_read_b64 v[114:115], v73
    v_lshlrev_b32_sdwa v76, 3, v46 dst_sel:DWORD dst_unused:UNUSED_PAD src0_sel:DWORD src1_sel:WORD_0
    v_lshrrev_b32 v20, 1, v17
    ds_read_b64 v[116:117], v74
    v_lshlrev_b32_sdwa v77, 3, v46 dst_sel:DWORD dst_unused:UNUSED_PAD src0_sel:DWORD src1_sel:WORD_1
    v_lshlrev_b32 v24, 2, v18
    ds_read_b64 v[118:119], v75
    v_lshlrev_b32_sdwa v78, 3, v47 dst_sel:DWORD dst_unused:UNUSED_PAD src0_sel:DWORD src1_sel:WORD_0
    v_sub_u32 v20, v20, v24
    ds_write_b128 v16, a[144:147] offset:2048
    s_waitcnt lgkmcnt(10)
    v_smfmac_f32_16x16x64_bf16 v[200:203], v[4:7], v[136:143], v184
    ds_read_b64 v[120:121], v76
    v_lshlrev_b32_sdwa v79, 3, v47 dst_sel:DWORD dst_unused:UNUSED_PAD src0_sel:DWORD src1_sel:WORD_1
    v_cmp_eq_u32 vcc, 0, v20
    buffer_load_dwordx4 v[44:47], v2, s[8:11], s59 offen offset:3072 sc1
    s_add_u32 s59, s59, 4096
    ds_read_b64 v[122:123], v77
    v_lshlrev_b32_sdwa v64, 3, v48 dst_sel:DWORD dst_unused:UNUSED_PAD src0_sel:DWORD src1_sel:WORD_0
    v_cndmask_b32 v24, 0, v21, vcc
    ds_read_b64 v[124:125], v78
    v_lshlrev_b32_sdwa v65, 3, v48 dst_sel:DWORD dst_unused:UNUSED_PAD src0_sel:DWORD src1_sel:WORD_1
    v_cmp_eq_u32 vcc, -8, v20
    ds_read_b64 v[126:127], v79
    v_lshlrev_b32_sdwa v66, 3, v49 dst_sel:DWORD dst_unused:UNUSED_PAD src0_sel:DWORD src1_sel:WORD_0
    v_cndmask_b32 v28, 0, v21, vcc
    v_cmp_eq_u32 vcc, 1, v20
    s_waitcnt lgkmcnt(9)
    v_smfmac_f32_16x16x64_bf16 v[200:203], v[4:7], v[104:111], v184
    buffer_store_dwordx4 v[196:199], v2, s[32:35], s64 offen offset:1024 sc1
    s_mul_i32 s51, s48, 6144
    s_add_u32 s51, s51, 1024
    s_add_u32 m0, s51, 131072
    s_nop 0
    buffer_load_dwordx4 v2, s[40:43], s51 offen lds
    ds_read_b64 v[128:129], v64
    v_lshlrev_b32_sdwa v67, 3, v49 dst_sel:DWORD dst_unused:UNUSED_PAD src0_sel:DWORD src1_sel:WORD_1
    v_cndmask_b32 v25, 0, v21, vcc
    ds_read_b64 v[130:131], v65
    v_lshlrev_b32_sdwa v68, 3, v50 dst_sel:DWORD dst_unused:UNUSED_PAD src0_sel:DWORD src1_sel:WORD_0
    v_cmp_eq_u32 vcc, -7, v20
    ds_read_b64 v[132:133], v66
    v_lshlrev_b32_sdwa v69, 3, v50 dst_sel:DWORD dst_unused:UNUSED_PAD src0_sel:DWORD src1_sel:WORD_1
    v_cndmask_b32 v29, 0, v21, vcc
    ds_read_b64 v[134:135], v67
    v_lshlrev_b32_sdwa v70, 3, v51 dst_sel:DWORD dst_unused:UNUSED_PAD src0_sel:DWORD src1_sel:WORD_0
    v_cmp_eq_u32 vcc, 2, v20
    s_nop 1
    v_cndmask_b32 v26, 0, v21, vcc
    ds_write_b128 v16, a[152:155] offset:3072
    s_waitcnt lgkmcnt(10)
    v_smfmac_f32_16x16x64_bf16 v[204:207], v[4:7], v[112:119], v184
    ds_read_b64 v[136:137], v68
    v_lshlrev_b32_sdwa v71, 3, v51 dst_sel:DWORD dst_unused:UNUSED_PAD src0_sel:DWORD src1_sel:WORD_1
    v_cmp_eq_u32 vcc, -6, v20
    buffer_load_dwordx4 v[48:51], v2, s[8:11], s59 offen offset:0 sc1
    ds_read_b64 v[138:139], v69
    v_lshlrev_b32_sdwa v72, 3, v52 dst_sel:DWORD dst_unused:UNUSED_PAD src0_sel:DWORD src1_sel:WORD_0
    v_cndmask_b32 v30, 0, v21, vcc
    ds_read_b64 v[140:141], v70
    v_lshlrev_b32_sdwa v73, 3, v52 dst_sel:DWORD dst_unused:UNUSED_PAD src0_sel:DWORD src1_sel:WORD_1
    v_cmp_eq_u32 vcc, 3, v20
    ds_read_b64 v[142:143], v71
    v_lshlrev_b32_sdwa v74, 3, v53 dst_sel:DWORD dst_unused:UNUSED_PAD src0_sel:DWORD src1_sel:WORD_0
    v_cndmask_b32 v27, 0, v21, vcc
    v_cmp_eq_u32 vcc, -5, v20
    s_waitcnt lgkmcnt(9)
    v_smfmac_f32_16x16x64_bf16 v[204:207], v[4:7], v[120:127], v184
    buffer_store_dwordx4 v[200:203], v2, s[32:35], s64 offen offset:2048 sc1
    s_mul_i32 s51, s48, 6144
    s_add_u32 s51, s51, 2048
    s_add_u32 m0, s51, 131072
    s_nop 0
    buffer_load_dwordx4 v2, s[40:43], s51 offen lds
    ds_read_b64 v[104:105], v72
    v_lshlrev_b32_sdwa v75, 3, v53 dst_sel:DWORD dst_unused:UNUSED_PAD src0_sel:DWORD src1_sel:WORD_1
    v_cndmask_b32 v31, 0, v21, vcc
    ds_read_b64 v[106:107], v73
    v_lshlrev_b32_sdwa v76, 3, v54 dst_sel:DWORD dst_unused:UNUSED_PAD src0_sel:DWORD src1_sel:WORD_0
    s_mul_i32 s53, s48, 1600
    ds_read_b64 v[108:109], v74
    v_lshlrev_b32_sdwa v77, 3, v54 dst_sel:DWORD dst_unused:UNUSED_PAD src0_sel:DWORD src1_sel:WORD_1
    s_add_u32 s53, s53, 155648
    ds_read_b64 v[110:111], v75
    v_lshlrev_b32_sdwa v78, 3, v55 dst_sel:DWORD dst_unused:UNUSED_PAD src0_sel:DWORD src1_sel:WORD_0
    v_lshl_add_u32 v23, v17, 2, s53
    s_waitcnt vmcnt(12)
    v_and_b32 v21, 12, v17
    s_waitcnt lgkmcnt(9)
    v_smfmac_f32_16x16x64_bf16 v[208:211], v[4:7], v[128:135], v184
    ds_read_b64 v[112:113], v76
    v_lshlrev_b32_sdwa v79, 3, v55 dst_sel:DWORD dst_unused:UNUSED_PAD src0_sel:DWORD src1_sel:WORD_1
    ds_write_b128 v16, a[160:163] offset:4096
    buffer_load_dwordx4 v[52:55], v2, s[8:11], s59 offen offset:1024 sc1
    ds_read_b64 v[114:115], v77
    v_lshlrev_b32_sdwa v64, 3, v56 dst_sel:DWORD dst_unused:UNUSED_PAD src0_sel:DWORD src1_sel:WORD_0
    v_add_u32 v21, s53, v21
    ds_read_b32 v144, v23 offset:0
    ds_read_b64 v[116:117], v78
    v_lshlrev_b32_sdwa v65, 3, v56 dst_sel:DWORD dst_unused:UNUSED_PAD src0_sel:DWORD src1_sel:WORD_1
    ds_read_b32 v145, v23 offset:64
    ds_read_b64 v[118:119], v79
    v_lshlrev_b32_sdwa v66, 3, v57 dst_sel:DWORD dst_unused:UNUSED_PAD src0_sel:DWORD src1_sel:WORD_0
    ds_read_b32 v146, v23 offset:128
    ds_read_b32 v147, v23 offset:192
    s_waitcnt lgkmcnt(13)
    v_smfmac_f32_16x16x64_bf16 v[208:211], v[4:7], v[136:143], v184
    buffer_store_dwordx4 v[204:207], v2, s[32:35], s64 offen offset:3072 sc1
    s_mul_i32 s51, s48, 6144
    s_add_u32 s51, s51, 3072
    s_add_u32 m0, s51, 131072
    s_nop 0
    buffer_load_dwordx4 v2, s[40:43], s51 offen lds
    ds_read_b64 v[120:121], v64
    v_lshlrev_b32_sdwa v67, 3, v57 dst_sel:DWORD dst_unused:UNUSED_PAD src0_sel:DWORD src1_sel:WORD_1
    ds_read_b32 v148, v23 offset:256
    ds_read_b64 v[122:123], v65
    v_lshlrev_b32_sdwa v68, 3, v58 dst_sel:DWORD dst_unused:UNUSED_PAD src0_sel:DWORD src1_sel:WORD_0
    ds_read_b32 v149, v23 offset:320
    ds_read_b64 v[124:125], v66
    v_lshlrev_b32_sdwa v69, 3, v58 dst_sel:DWORD dst_unused:UNUSED_PAD src0_sel:DWORD src1_sel:WORD_1
    ds_read_b32 v150, v21 offset:384
    ds_read_b64 v[126:127], v67
    v_lshlrev_b32_sdwa v70, 3, v59 dst_sel:DWORD dst_unused:UNUSED_PAD src0_sel:DWORD src1_sel:WORD_0
    ds_read_b32 v151, v23 offset:400
    s_waitcnt vmcnt(14)
    ds_read_b32 v152, v23 offset:464
    s_waitcnt lgkmcnt(15)
    v_smfmac_f32_16x16x64_bf16 v[212:215], v[4:7], v[104:111], v184
    ds_read_b64 v[128:129], v68
    v_lshlrev_b32_sdwa v71, 3, v59 dst_sel:DWORD dst_unused:UNUSED_PAD src0_sel:DWORD src1_sel:WORD_1
    ds_write_b128 v16, a[168:171] offset:5120
    buffer_load_dwordx4 v[56:59], v2, s[8:11], s59 offen offset:2048 sc1
    ds_read_b64 v[130:131], v69
    v_lshlrev_b32_sdwa v72, 3, v60 dst_sel:DWORD dst_unused:UNUSED_PAD src0_sel:DWORD src1_sel:WORD_0
    ds_read_b32 v153, v23 offset:528
    ds_read_b64 v[132:133], v70
    v_lshlrev_b32_sdwa v73, 3, v60 dst_sel:DWORD dst_unused:UNUSED_PAD src0_sel:DWORD src1_sel:WORD_1
    ds_read_b32 v154, v23 offset:592
    ds_read_b64 v[134:135], v71
    v_lshlrev_b32_sdwa v74, 3, v61 dst_sel:DWORD dst_unused:UNUSED_PAD src0_sel:DWORD src1_sel:WORD_0
    ds_read_b32 v155, v23 offset:656
    ds_read_b32 v156, v23 offset:720
    ds_read_b32 v157, v21 offset:784
    s_waitcnt lgkmcnt(15)
    v_smfmac_f32_16x16x64_bf16 v[212:215], v[4:7], v[112:119], v184
    buffer_store_dwordx4 v[208:211], v2, s[32:35], s54 offen offset:0 sc1
    s_mul_i32 s51, s48, 6144
    s_add_u32 s51, s51, 4096
    s_add_u32 m0, s51, 131072
    s_nop 0
    buffer_load_dwordx4 v2, s[40:43], s51 offen lds
    ds_read_b64 v[136:137], v72
    v_lshlrev_b32_sdwa v75, 3, v61 dst_sel:DWORD dst_unused:UNUSED_PAD src0_sel:DWORD src1_sel:WORD_1
    ds_read_b32 v158, v23 offset:800
    ds_read_b64 v[138:139], v73
    v_lshlrev_b32_sdwa v76, 3, v62 dst_sel:DWORD dst_unused:UNUSED_PAD src0_sel:DWORD src1_sel:WORD_0
    ds_read_b32 v159, v23 offset:864
    ds_read_b64 v[140:141], v74
    v_lshlrev_b32_sdwa v77, 3, v62 dst_sel:DWORD dst_unused:UNUSED_PAD src0_sel:DWORD src1_sel:WORD_1
    ds_read_b32 v160, v23 offset:928
    ds_read_b64 v[142:143], v75
    v_lshlrev_b32_sdwa v78, 3, v63 dst_sel:DWORD dst_unused:UNUSED_PAD src0_sel:DWORD src1_sel:WORD_0
    ds_read_b32 v161, v23 offset:992
    s_waitcnt vmcnt(16)
    ds_read_b32 v162, v23 offset:1056
    s_waitcnt lgkmcnt(15)
    v_smfmac_f32_16x16x64_bf16 v[216:219], v[4:7], v[120:127], v184
    ds_read_b64 v[104:105], v76
    v_lshlrev_b32_sdwa v79, 3, v63 dst_sel:DWORD dst_unused:UNUSED_PAD src0_sel:DWORD src1_sel:WORD_1
    ds_write_b128 v16, a[176:179] offset:6144
    buffer_load_dwordx4 v[60:63], v2, s[8:11], s59 offen offset:3072 sc1
    s_add_u32 s59, s59, 4096
    ds_read_b64 v[106:107], v77
    v_lshlrev_b32_sdwa v64, 3, v32 dst_sel:DWORD dst_unused:UNUSED_PAD src0_sel:DWORD src1_sel:WORD_0
    ds_read_b32 v163, v23 offset:1120
    ds_read_b64 v[108:109], v78
    v_lshlrev_b32_sdwa v65, 3, v32 dst_sel:DWORD dst_unused:UNUSED_PAD src0_sel:DWORD src1_sel:WORD_1
    ds_read_b32 v164, v21 offset:1184
    ds_read_b64 v[110:111], v79
    v_lshlrev_b32_sdwa v66, 3, v33 dst_sel:DWORD dst_unused:UNUSED_PAD src0_sel:DWORD src1_sel:WORD_0
    ds_read_b32 v165, v23 offset:1200
    ds_read_b32 v166, v23 offset:1264
    s_waitcnt lgkmcnt(15)
    v_smfmac_f32_16x16x64_bf16 v[216:219], v[4:7], v[128:135], v184
    buffer_store_dwordx4 v[212:215], v2, s[32:35], s54 offen offset:1024 sc1
    s_mul_i32 s51, s48, 6144
    s_add_u32 s51, s51, 5120
    s_add_u32 m0, s51, 131072
    s_nop 0
    buffer_load_dwordx4 v2, s[40:43], s51 offen lds
    ds_read_b64 v[112:113], v64
    v_lshlrev_b32_sdwa v67, 3, v33 dst_sel:DWORD dst_unused:UNUSED_PAD src0_sel:DWORD src1_sel:WORD_1
    ds_read_b32 v167, v23 offset:1328
    ds_read_b64 v[114:115], v65
    v_lshlrev_b32_sdwa v68, 3, v34 dst_sel:DWORD dst_unused:UNUSED_PAD src0_sel:DWORD src1_sel:WORD_0
    ds_read_b32 v168, v23 offset:1392
    ds_read_b64 v[116:117], v66
    v_lshlrev_b32_sdwa v69, 3, v34 dst_sel:DWORD dst_unused:UNUSED_PAD src0_sel:DWORD src1_sel:WORD_1
    ds_read_b32 v169, v23 offset:1456
    ds_read_b32 v170, v23 offset:1520
    ds_read_b64 v[118:119], v67
    v_lshlrev_b32_sdwa v70, 3, v35 dst_sel:DWORD dst_unused:UNUSED_PAD src0_sel:DWORD src1_sel:WORD_0
    ds_read_b32 v171, v21 offset:1584
    s_waitcnt vmcnt(18)
    v_and_b32 v20, 3, v17
    s_waitcnt lgkmcnt(15)
    v_smfmac_f32_16x16x64_bf16 v[220:223], v[4:7], v[136:143], v184
    ds_read_b64 v[120:121], v68
    v_lshlrev_b32_sdwa v71, 3, v35 dst_sel:DWORD dst_unused:UNUSED_PAD src0_sel:DWORD src1_sel:WORD_1
    ds_write_b128 v16, a[184:187] offset:7168
    ds_read_b64 v[122:123], v69
    v_lshlrev_b32_sdwa v72, 3, v36 dst_sel:DWORD dst_unused:UNUSED_PAD src0_sel:DWORD src1_sel:WORD_0
    v_cmp_eq_u32 vcc, 0, v20
    ds_read_b64 v[124:125], v70
    v_lshlrev_b32_sdwa v73, 3, v36 dst_sel:DWORD dst_unused:UNUSED_PAD src0_sel:DWORD src1_sel:WORD_1
    v_mov_b32 v20, 1000
    ds_read_b64 v[126:127], v71
    v_lshlrev_b32_sdwa v74, 3, v37 dst_sel:DWORD dst_unused:UNUSED_PAD src0_sel:DWORD src1_sel:WORD_0
    s_waitcnt lgkmcnt(5)
    v_cndmask_b32 v150, v20, v150, vcc
    v_smfmac_f32_16x16x64_bf16 v[220:223], v[4:7], v[104:111], v184
    buffer_store_dwordx4 v[216:219], v2, s[32:35], s54 offen offset:2048 sc1
    ds_read_b64 v[128:129], v72
    v_lshlrev_b32_sdwa v75, 3, v37 dst_sel:DWORD dst_unused:UNUSED_PAD src0_sel:DWORD src1_sel:WORD_1
    v_cndmask_b32 v157, v20, v157, vcc
    ds_read_b64 v[130:131], v73
    v_lshlrev_b32_sdwa v76, 3, v38 dst_sel:DWORD dst_unused:UNUSED_PAD src0_sel:DWORD src1_sel:WORD_0
    v_cndmask_b32 v164, v20, v164, vcc
    ds_read_b64 v[132:133], v74
    v_lshlrev_b32_sdwa v77, 3, v38 dst_sel:DWORD dst_unused:UNUSED_PAD src0_sel:DWORD src1_sel:WORD_1
    v_cndmask_b32 v171, v20, v171, vcc
    ds_read_b64 v[134:135], v75
    v_lshlrev_b32_sdwa v78, 3, v39 dst_sel:DWORD dst_unused:UNUSED_PAD src0_sel:DWORD src1_sel:WORD_0
    v_bfe_u32 v23, v144, 2, 2
    s_waitcnt vmcnt(18)
    v_xor_b32 v23, v23, v18
    v_smfmac_f32_16x16x64_bf16 v[224:227], v[4:7], v[112:119], v184
    ds_read_b64 v[136:137], v76
    v_lshlrev_b32_sdwa v79, 3, v39 dst_sel:DWORD dst_unused:UNUSED_PAD src0_sel:DWORD src1_sel:WORD_1
    v_lshl_or_b32 v144, v144, 2, v23
    ds_write_b128 v16, a[192:195] offset:8192
    ds_read_b64 v[138:139], v77
    v_lshlrev_b32_sdwa v64, 3, v40 dst_sel:DWORD dst_unused:UNUSED_PAD src0_sel:DWORD src1_sel:WORD_0
    v_lshlrev_b32 v144, 4, v144
    ds_read_b64 v[140:141], v78
    v_lshlrev_b32_sdwa v65, 3, v40 dst_sel:DWORD dst_unused:UNUSED_PAD src0_sel:DWORD src1_sel:WORD_1
    v_bfe_u32 v23, v145, 2, 2
    ds_read_b64 v[142:143], v79
    v_lshlrev_b32_sdwa v66, 3, v41 dst_sel:DWORD dst_unused:UNUSED_PAD src0_sel:DWORD src1_sel:WORD_0
    v_xor_b32 v23, v23, v18
    v_lshl_or_b32 v145, v145, 2, v23
    s_waitcnt lgkmcnt(9)
    v_smfmac_f32_16x16x64_bf16 v[224:227], v[4:7], v[120:127], v184
    buffer_store_dwordx4 v[220:223], v2, s[32:35], s54 offen offset:3072 sc1
    ds_read_b64 v[104:105], v64
    v_lshlrev_b32_sdwa v67, 3, v41 dst_sel:DWORD dst_unused:UNUSED_PAD src0_sel:DWORD src1_sel:WORD_1
    v_lshlrev_b32 v145, 4, v145
    ds_read_b64 v[106:107], v65
    v_lshlrev_b32_sdwa v68, 3, v42 dst_sel:DWORD dst_unused:UNUSED_PAD src0_sel:DWORD src1_sel:WORD_0
    v_bfe_u32 v23, v146, 2, 2
    ds_read_b64 v[108:109], v66
    v_lshlrev_b32_sdwa v69, 3, v42 dst_sel:DWORD dst_unused:UNUSED_PAD src0_sel:DWORD src1_sel:WORD_1
    v_xor_b32 v23, v23, v18
    ds_read_b64 v[110:111], v67
    v_lshlrev_b32_sdwa v70, 3, v43 dst_sel:DWORD dst_unused:UNUSED_PAD src0_sel:DWORD src1_sel:WORD_0
    v_lshl_or_b32 v146, v146, 2, v23
    s_waitcnt vmcnt(16)
    v_lshlrev_b32 v146, 4, v146
    s_waitcnt lgkmcnt(9)
    v_smfmac_f32_16x16x64_bf16 v[228:231], v[4:7], v[128:135], v184
    ds_read_b64 v[112:113], v68
    v_lshlrev_b32_sdwa v71, 3, v43 dst_sel:DWORD dst_unused:UNUSED_PAD src0_sel:DWORD src1_sel:WORD_1
    v_bfe_u32 v23, v147, 2, 2
    ds_read_b64 v[114:115], v69
    v_lshlrev_b32_sdwa v72, 3, v44 dst_sel:DWORD dst_unused:UNUSED_PAD src0_sel:DWORD src1_sel:WORD_0
    ds_write_b128 v16, a[200:203] offset:9216
    ds_read_b64 v[116:117], v70
    v_lshlrev_b32_sdwa v73, 3, v44 dst_sel:DWORD dst_unused:UNUSED_PAD src0_sel:DWORD src1_sel:WORD_1
    v_xor_b32 v23, v23, v18
    ds_read_b64 v[118:119], v71
    v_lshlrev_b32_sdwa v74, 3, v45 dst_sel:DWORD dst_unused:UNUSED_PAD src0_sel:DWORD src1_sel:WORD_0
    v_lshl_or_b32 v147, v147, 2, v23
    v_lshlrev_b32 v147, 4, v147
    v_bfe_u32 v23, v148, 2, 2
    s_waitcnt lgkmcnt(9)
    v_smfmac_f32_16x16x64_bf16 v[228:231], v[4:7], v[136:143], v184
    ds_read_b64 v[120:121], v72
    v_lshlrev_b32_sdwa v75, 3, v45 dst_sel:DWORD dst_unused:UNUSED_PAD src0_sel:DWORD src1_sel:WORD_1
    v_xor_b32 v23, v23, v18
    ds_read_b64 v[122:123], v73
    v_lshlrev_b32_sdwa v76, 3, v46 dst_sel:DWORD dst_unused:UNUSED_PAD src0_sel:DWORD src1_sel:WORD_0
    v_lshl_or_b32 v148, v148, 2, v23
    ds_read_b64 v[124:125], v74
    v_lshlrev_b32_sdwa v77, 3, v46 dst_sel:DWORD dst_unused:UNUSED_PAD src0_sel:DWORD src1_sel:WORD_1
    v_lshlrev_b32 v148, 4, v148
    ds_read_b64 v[126:127], v75
    v_lshlrev_b32_sdwa v78, 3, v47 dst_sel:DWORD dst_unused:UNUSED_PAD src0_sel:DWORD src1_sel:WORD_0
    v_bfe_u32 v23, v149, 2, 2
    s_waitcnt vmcnt(13)
    v_xor_b32 v23, v23, v18
    s_waitcnt lgkmcnt(9)
    v_smfmac_f32_16x16x64_bf16 v[232:235], v[4:7], v[104:111], v184
    ds_read_b64 v[128:129], v76
    v_lshlrev_b32_sdwa v79, 3, v47 dst_sel:DWORD dst_unused:UNUSED_PAD src0_sel:DWORD src1_sel:WORD_1
    v_lshl_or_b32 v149, v149, 2, v23
    ds_read_b64 v[130:131], v77
    v_lshlrev_b32_sdwa v64, 3, v48 dst_sel:DWORD dst_unused:UNUSED_PAD src0_sel:DWORD src1_sel:WORD_0
    ds_write_b128 v16, a[208:211] offset:10240
    ds_read_b64 v[132:133], v78
    v_lshlrev_b32_sdwa v65, 3, v48 dst_sel:DWORD dst_unused:UNUSED_PAD src0_sel:DWORD src1_sel:WORD_1
    v_lshlrev_b32 v149, 4, v149
    ds_read_b64 v[134:135], v79
    v_lshlrev_b32_sdwa v66, 3, v49 dst_sel:DWORD dst_unused:UNUSED_PAD src0_sel:DWORD src1_sel:WORD_0
    v_bfe_u32 v23, v150, 2, 2
    v_xor_b32 v23, v23, v18
    s_waitcnt lgkmcnt(9)
    v_smfmac_f32_16x16x64_bf16 v[232:235], v[4:7], v[112:119], v184
    ds_read_b64 v[136:137], v64
    v_lshlrev_b32_sdwa v67, 3, v49 dst_sel:DWORD dst_unused:UNUSED_PAD src0_sel:DWORD src1_sel:WORD_1
    v_lshl_or_b32 v150, v150, 2, v23
    ds_read_b64 v[138:139], v65
    v_lshlrev_b32_sdwa v68, 3, v50 dst_sel:DWORD dst_unused:UNUSED_PAD src0_sel:DWORD src1_sel:WORD_0
    v_lshlrev_b32 v150, 4, v150
    v_bfe_u32 v23, v151, 2, 2
    ds_read_b64 v[140:141], v66
    v_lshlrev_b32_sdwa v69, 3, v50 dst_sel:DWORD dst_unused:UNUSED_PAD src0_sel:DWORD src1_sel:WORD_1
    v_xor_b32 v23, v23, v18
    ds_read_b64 v[142:143], v67
    v_lshlrev_b32_sdwa v70, 3, v51 dst_sel:DWORD dst_unused:UNUSED_PAD src0_sel:DWORD src1_sel:WORD_0
    v_lshl_or_b32 v151, v151, 2, v23
    s_waitcnt vmcnt(10)
    v_lshlrev_b32 v151, 4, v151
    s_waitcnt lgkmcnt(9)
    v_smfmac_f32_16x16x64_bf16 v[236:239], v[4:7], v[120:127], v184
    ds_read_b64 v[104:105], v68
    v_lshlrev_b32_sdwa v71, 3, v51 dst_sel:DWORD dst_unused:UNUSED_PAD src0_sel:DWORD src1_sel:WORD_1
    v_bfe_u32 v23, v152, 2, 2
    ds_read_b64 v[106:107], v69
    v_lshlrev_b32_sdwa v72, 3, v52 dst_sel:DWORD dst_unused:UNUSED_PAD src0_sel:DWORD src1_sel:WORD_0
    ds_write_b128 v16, a[216:219] offset:11264
    ds_read_b64 v[108:109], v70
    v_lshlrev_b32_sdwa v73, 3, v52 dst_sel:DWORD dst_unused:UNUSED_PAD src0_sel:DWORD src1_sel:WORD_1
    v_xor_b32 v23, v23, v18
    ds_read_b64 v[110:111], v71
    v_lshlrev_b32_sdwa v74, 3, v53 dst_sel:DWORD dst_unused:UNUSED_PAD src0_sel:DWORD src1_sel:WORD_0
    v_lshl_or_b32 v152, v152, 2, v23
    v_lshlrev_b32 v152, 4, v152
    s_waitcnt lgkmcnt(9)
    v_smfmac_f32_16x16x64_bf16 v[236:239], v[4:7], v[128:135], v184
    ds_read_b64 v[112:113], v72
    v_lshlrev_b32_sdwa v75, 3, v53 dst_sel:DWORD dst_unused:UNUSED_PAD src0_sel:DWORD src1_sel:WORD_1
    v_bfe_u32 v23, v153, 2, 2
    ds_read_b64 v[114:115], v73
    v_lshlrev_b32_sdwa v76, 3, v54 dst_sel:DWORD dst_unused:UNUSED_PAD src0_sel:DWORD src1_sel:WORD_0
    v_xor_b32 v23, v23, v18
    ds_read_b64 v[116:117], v74
    v_lshlrev_b32_sdwa v77, 3, v54 dst_sel:DWORD dst_unused:UNUSED_PAD src0_sel:DWORD src1_sel:WORD_1
    v_lshl_or_b32 v153, v153, 2, v23
    ds_read_b64 v[118:119], v75
    v_lshlrev_b32_sdwa v78, 3, v55 dst_sel:DWORD dst_unused:UNUSED_PAD src0_sel:DWORD src1_sel:WORD_0
    v_lshlrev_b32 v153, 4, v153
    s_waitcnt vmcnt(7)
    v_bfe_u32 v23, v154, 2, 2
    v_xor_b32 v23, v23, v18
    s_waitcnt lgkmcnt(9)
    v_smfmac_f32_16x16x64_bf16 v[240:243], v[4:7], v[136:143], v184
    ds_read_b64 v[120:121], v76
    v_lshlrev_b32_sdwa v79, 3, v55 dst_sel:DWORD dst_unused:UNUSED_PAD src0_sel:DWORD src1_sel:WORD_1
    v_lshl_or_b32 v154, v154, 2, v23
    ds_read_b64 v[122:123], v77
    v_lshlrev_b32_sdwa v64, 3, v56 dst_sel:DWORD dst_unused:UNUSED_PAD src0_sel:DWORD src1_sel:WORD_0
    ds_write_b128 v16, a[224:227] offset:12288
    ds_read_b64 v[124:125], v78
    v_lshlrev_b32_sdwa v65, 3, v56 dst_sel:DWORD dst_unused:UNUSED_PAD src0_sel:DWORD src1_sel:WORD_1
    v_lshlrev_b32 v154, 4, v154
    ds_read_b64 v[126:127], v79
    v_lshlrev_b32_sdwa v66, 3, v57 dst_sel:DWORD dst_unused:UNUSED_PAD src0_sel:DWORD src1_sel:WORD_0
    v_bfe_u32 v23, v155, 2, 2
    v_xor_b32 v23, v23, v18
    s_waitcnt lgkmcnt(9)
    v_smfmac_f32_16x16x64_bf16 v[240:243], v[4:7], v[104:111], v184
    ds_read_b64 v[128:129], v64
    v_lshlrev_b32_sdwa v67, 3, v57 dst_sel:DWORD dst_unused:UNUSED_PAD src0_sel:DWORD src1_sel:WORD_1
    v_lshl_or_b32 v155, v155, 2, v23
    ds_read_b64 v[130:131], v65
    v_lshlrev_b32_sdwa v68, 3, v58 dst_sel:DWORD dst_unused:UNUSED_PAD src0_sel:DWORD src1_sel:WORD_0
    v_lshlrev_b32 v155, 4, v155
    ds_read_b64 v[132:133], v66
    v_lshlrev_b32_sdwa v69, 3, v58 dst_sel:DWORD dst_unused:UNUSED_PAD src0_sel:DWORD src1_sel:WORD_1
    v_bfe_u32 v23, v156, 2, 2
    ds_read_b64 v[134:135], v67
    v_lshlrev_b32_sdwa v70, 3, v59 dst_sel:DWORD dst_unused:UNUSED_PAD src0_sel:DWORD src1_sel:WORD_0
    v_xor_b32 v23, v23, v18
    s_waitcnt vmcnt(4)
    v_lshl_or_b32 v156, v156, 2, v23
    s_waitcnt lgkmcnt(9)
    v_smfmac_f32_16x16x64_bf16 v[244:247], v[4:7], v[112:119], v184
    ds_read_b64 v[136:137], v68
    v_lshlrev_b32_sdwa v71, 3, v59 dst_sel:DWORD dst_unused:UNUSED_PAD src0_sel:DWORD src1_sel:WORD_1
    v_lshlrev_b32 v156, 4, v156
    ds_read_b64 v[138:139], v69
    v_lshlrev_b32_sdwa v72, 3, v60 dst_sel:DWORD dst_unused:UNUSED_PAD src0_sel:DWORD src1_sel:WORD_0
    v_bfe_u32 v23, v157, 2, 2
    ds_read_b64 v[140:141], v70
    v_lshlrev_b32_sdwa v73, 3, v60 dst_sel:DWORD dst_unused:UNUSED_PAD src0_sel:DWORD src1_sel:WORD_1
    ds_write_b128 v16, a[232:235] offset:13312
    v_xor_b32 v23, v23, v18
    ds_read_b64 v[142:143], v71
    v_lshlrev_b32_sdwa v74, 3, v61 dst_sel:DWORD dst_unused:UNUSED_PAD src0_sel:DWORD src1_sel:WORD_0
    v_lshl_or_b32 v157, v157, 2, v23
    v_lshlrev_b32 v157, 4, v157
    s_waitcnt lgkmcnt(9)
    v_smfmac_f32_16x16x64_bf16 v[244:247], v[4:7], v[120:127], v184
    ds_read_b64 v[104:105], v72
    v_lshlrev_b32_sdwa v75, 3, v61 dst_sel:DWORD dst_unused:UNUSED_PAD src0_sel:DWORD src1_sel:WORD_1
    v_bfe_u32 v23, v158, 2, 2
    ds_read_b64 v[106:107], v73
    v_lshlrev_b32_sdwa v76, 3, v62 dst_sel:DWORD dst_unused:UNUSED_PAD src0_sel:DWORD src1_sel:WORD_0
    v_xor_b32 v23, v23, v18
    ds_read_b64 v[108:109], v74
    v_lshlrev_b32_sdwa v77, 3, v62 dst_sel:DWORD dst_unused:UNUSED_PAD src0_sel:DWORD src1_sel:WORD_1
    v_lshl_or_b32 v158, v158, 2, v23
    ds_read_b64 v[110:111], v75
    v_lshlrev_b32_sdwa v78, 3, v63 dst_sel:DWORD dst_unused:UNUSED_PAD src0_sel:DWORD src1_sel:WORD_0
    v_lshlrev_b32 v158, 4, v158
    v_bfe_u32 v23, v159, 2, 2
    s_waitcnt lgkmcnt(9)
    v_smfmac_f32_16x16x64_bf16 v[248:251], v[4:7], v[128:135], v184
    ds_read_b64 v[112:113], v76
    v_lshlrev_b32_sdwa v79, 3, v63 dst_sel:DWORD dst_unused:UNUSED_PAD src0_sel:DWORD src1_sel:WORD_1
    v_xor_b32 v23, v23, v18
    ds_read_b64 v[114:115], v77
    v_lshl_or_b32 v159, v159, 2, v23
    ds_read_b64 v[116:117], v78
    ds_write_b128 v16, a[240:243] offset:14336
    ds_read_b64 v[118:119], v79
    v_lshlrev_b32 v159, 4, v159
    ds_write_b128 v16, a[248:251] offset:15360
    s_waitcnt lgkmcnt(10)
    v_smfmac_f32_16x16x64_bf16 v[248:251], v[4:7], v[136:143], v184
    s_waitcnt lgkmcnt(6)
    v_smfmac_f32_16x16x64_bf16 v[252:255], v[4:7], v[104:111], v184
    s_waitcnt lgkmcnt(1)
    v_smfmac_f32_16x16x64_bf16 v[252:255], v[4:7], v[112:119], v184
    s_waitcnt lgkmcnt(0)
    s_waitcnt vmcnt(0)
    s_mov_b64 exec, 1
    buffer_store_dword v9, v9, s[32:35], s66 offen sc1
    s_mov_b64 exec, -1
    v_add_u32 v16, 16384, v16
    s_barrier
    ds_read_b64 a[0:1], v19 offset:0
    ds_read_b64 a[2:3], v19 offset:8
    ds_read_b64 a[4:5], v19 offset:64
    ds_read_b64 a[6:7], v19 offset:72
    ds_read_b64 a[8:9], v19 offset:128
    ds_read_b64 a[10:11], v19 offset:136
    ds_read_b64 a[12:13], v19 offset:192
    ds_read_b64 a[14:15], v19 offset:200
    ds_read_b64 a[16:17], v19 offset:3200
    ds_read_b64 a[18:19], v19 offset:3208
    ds_read_b64 a[20:21], v19 offset:3264
    ds_read_b64 a[22:23], v19 offset:3272
    ds_read_b64 a[24:25], v19 offset:3328
    ds_read_b64 a[26:27], v19 offset:3336
    ds_read_b64 a[28:29], v19 offset:3392
    ds_read_b64 a[30:31], v19 offset:3400
    ds_read_b64 a[32:33], v19 offset:6400
    ds_read_b64 a[34:35], v19 offset:6408
    ds_read_b64 a[36:37], v19 offset:6464
    ds_read_b64 a[38:39], v19 offset:6472
    ds_read_b64 a[40:41], v19 offset:6528
    ds_read_b64 a[42:43], v19 offset:6536
    ds_read_b64 a[44:45], v19 offset:6592
    ds_read_b64 a[46:47], v19 offset:6600
    ds_read_b64 a[48:49], v19 offset:9600
    ds_read_b64 a[50:51], v19 offset:9608
    ds_read_b64 a[52:53], v19 offset:9664
    ds_read_b64 a[54:55], v19 offset:9672
    ds_read_b64 a[56:57], v19 offset:9728
    ds_read_b64 a[58:59], v19 offset:9736
    ds_read_b64 a[60:61], v19 offset:9792
    ds_read_b64 a[62:63], v19 offset:9800
    ds_read_b64 a[64:65], v19 offset:12800
    ds_read_b64 a[66:67], v19 offset:12808
    ds_read_b64 a[68:69], v19 offset:12864
    ds_read_b64 a[70:71], v19 offset:12872
    ds_read_b64 a[72:73], v19 offset:12928
    ds_read_b64 a[74:75], v19 offset:12936
    ds_read_b64 a[76:77], v19 offset:12992
    ds_read_b64 a[78:79], v19 offset:13000
    ds_read_b64 a[80:81], v19 offset:16000
    ds_read_b64 a[82:83], v19 offset:16008
    ds_read_b64 a[84:85], v19 offset:16064
    ds_read_b64 a[86:87], v19 offset:16072
    ds_read_b64 a[88:89], v19 offset:16128
    ds_read_b64 a[90:91], v19 offset:16136
    ds_read_b64 a[92:93], v19 offset:16192
    ds_read_b64 a[94:95], v19 offset:16200
    ds_read_b64 a[96:97], v176 offset:19200
    ds_read_b64 a[98:99], v176 offset:19208
    ds_read_b64 a[100:101], v176 offset:19264
    ds_read_b64 a[102:103], v176 offset:19272
    ds_read_b64 a[104:105], v176 offset:19328
    ds_read_b64 a[106:107], v176 offset:19336
    ds_read_b64 a[108:109], v176 offset:19392
    ds_read_b64 a[110:111], v176 offset:19400
    ds_write_b128 v16, a[132:135] offset:47680
    ds_write_b128 v16, a[140:143] offset:48704
    ds_write_b128 v16, a[148:151] offset:49728
    ds_write_b128 v16, a[156:159] offset:50752
    s_waitcnt lgkmcnt(4)
    v_mfma_f32_16x16x32_bf16 v[32:35], a[0:3], v[24:27], 0
    s_mov_b32 s51, 41984
    v_mul_lo_u32 v20, v18, s51
    v_mfma_f32_16x16x32_bf16 v[36:39], a[0:3], v[28:31], 0
    ds_write_b128 v16, a[164:167] offset:51776
    v_mfma_f32_16x16x32_bf16 v[40:43], a[4:7], v[24:27], 0
    v_lshl_add_u32 v20, v17, 2, v20
    s_lshl_b32 s67, s50, 2
    v_mfma_f32_16x16x32_bf16 v[44:47], a[4:7], v[28:31], 0
    s_add_u32 s67, s67, s48
    s_mul_i32 s67, s67, 1343488
    v_mfma_f32_16x16x32_bf16 v[48:51], a[8:11], v[24:27], 0
    s_lshl_b32 s51, s49, 6
    s_add_u32 s67, s67, s51
    v_mfma_f32_16x16x32_bf16 v[52:55], a[8:11], v[28:31], 0
    ds_write_b128 v16, a[172:175] offset:52800
    v_mfma_f32_16x16x32_bf16 v[56:59], a[96:99], v[24:27], 0
    s_add_u32 s67, s67, 1081344
    s_lshl_b32 s51, s48, 13
    v_mfma_f32_16x16x32_bf16 v[60:63], a[16:19], v[28:31], 0
    s_add_u32 s53, s51, s65
    s_add_u32 s54, s53, 4096
    v_mfma_f32_16x16x32_bf16 v[64:67], a[20:23], v[24:27], 0
    s_mov_b32 s77, 0xbdd2d3e8
    v_mov_b32 v22, 0xc0135761
    v_mfma_f32_16x16x32_bf16 v[68:71], a[20:23], v[28:31], 0
    ds_write_b128 v16, a[180:183] offset:53824
    v_mfma_f32_16x16x32_bf16 v[72:75], a[24:27], v[24:27], 0
    v_mov_b32 v188, 0
    v_mov_b32 v189, 0
    v_mfma_f32_16x16x32_bf16 v[76:79], a[24:27], v[28:31], 0
    v_mov_b32 v190, 0
    v_mov_b32 v191, 0
    v_mfma_f32_16x16x32_bf16 v[80:83], a[96:99], v[28:31], 0
    v_mov_b32 v1, 0
    v_mov_b32 v3, 0
    v_mfma_f32_16x16x32_bf16 v[84:87], a[36:39], v[24:27], 0
    ds_write_b128 v16, a[188:191] offset:54848
    v_mfma_f32_16x16x32_bf16 v[88:91], a[36:39], v[28:31], 0
    v_mov_b32 v8, 0
    v_mov_b32 v10, 0
    v_mfma_f32_16x16x32_bf16 v[92:95], a[40:43], v[24:27], 0
    v_bfe_u32 v23, v160, 2, 2
    v_xor_b32 v23, v23, v18
    v_mfma_f32_16x16x32_bf16 v[96:99], a[40:43], v[28:31], 0
    v_lshl_or_b32 v160, v160, 2, v23
    v_lshlrev_b32 v160, 4, v160
    v_mfma_f32_16x16x32_bf16 v[100:103], a[100:103], v[24:27], 0
    ds_write_b128 v16, a[196:199] offset:55872
    v_mfma_f32_16x16x32_bf16 v[104:107], a[52:55], v[28:31], 0
    v_bfe_u32 v23, v161, 2, 2
    v_xor_b32 v23, v23, v18
    v_mfma_f32_16x16x32_bf16 v[108:111], a[56:59], v[24:27], 0
    v_lshl_or_b32 v161, v161, 2, v23
    v_lshlrev_b32 v161, 4, v161
    v_mfma_f32_16x16x32_bf16 v[112:115], a[56:59], v[28:31], 0
    v_bfe_u32 v23, v162, 2, 2
    v_xor_b32 v23, v23, v18
    v_mfma_f32_16x16x32_bf16 v[116:119], a[100:103], v[28:31], 0
    ds_write_b128 v16, a[204:207] offset:56896
    v_mfma_f32_16x16x32_bf16 v[120:123], a[72:75], v[24:27], 0
    v_lshl_or_b32 v162, v162, 2, v23
    v_lshlrev_b32 v162, 4, v162
    v_mfma_f32_16x16x32_bf16 v[124:127], a[72:75], v[28:31], 0
    v_bfe_u32 v23, v163, 2, 2
    v_xor_b32 v23, v23, v18
    v_mfma_f32_16x16x32_bf16 v[128:131], a[104:107], v[24:27], 0
    v_lshl_or_b32 v163, v163, 2, v23
    v_lshlrev_b32 v163, 4, v163
    v_mfma_f32_16x16x32_bf16 v[132:135], a[88:91], v[28:31], 0
    ds_write_b128 v16, a[212:215] offset:57920
    v_mfma_f32_16x16x32_bf16 v[136:139], a[104:107], v[28:31], 0
    v_bfe_u32 v23, v164, 2, 2
    v_xor_b32 v23, v23, v18
    v_mfma_f32_16x16x32_bf16 v[140:143], a[108:111], v[172:175], 0
    v_lshl_or_b32 v164, v164, 2, v23
    v_lshlrev_b32 v164, 4, v164
    v_mfma_f32_16x16x32_bf16 v[36:39], v[24:27], a[16:19], v[36:39]
    v_bfe_u32 v23, v165, 2, 2
    v_xor_b32 v23, v23, v18
    v_mfma_f32_16x16x32_bf16 v[40:43], v[24:27], a[32:35], v[40:43]
    ds_write_b128 v16, a[220:223] offset:58944
    v_mfma_f32_16x16x32_bf16 v[44:47], v[24:27], a[48:51], v[44:47]
    v_lshl_or_b32 v165, v165, 2, v23
    v_lshlrev_b32 v165, 4, v165
    v_mfma_f32_16x16x32_bf16 v[48:51], v[24:27], a[64:67], v[48:51]
    v_bfe_u32 v23, v166, 2, 2
    v_xor_b32 v23, v23, v18
    v_mfma_f32_16x16x32_bf16 v[52:55], v[24:27], a[80:83], v[52:55]
    v_lshl_or_b32 v166, v166, 2, v23
    v_lshlrev_b32 v166, 4, v166
    v_mfma_f32_16x16x32_bf16 v[56:59], v[172:175], a[12:15], v[56:59]
    ds_write_b128 v16, a[228:231] offset:59968
    v_mfma_f32_16x16x32_bf16 v[64:67], v[28:31], a[32:35], v[64:67]
    v_bfe_u32 v23, v167, 2, 2
    v_xor_b32 v23, v23, v18
    v_mfma_f32_16x16x32_bf16 v[68:71], v[28:31], a[48:51], v[68:71]
    v_lshl_or_b32 v167, v167, 2, v23
    v_lshlrev_b32 v167, 4, v167
    v_mfma_f32_16x16x32_bf16 v[72:75], v[28:31], a[64:67], v[72:75]
    v_bfe_u32 v23, v168, 2, 2
    v_xor_b32 v23, v23, v18
    v_mfma_f32_16x16x32_bf16 v[76:79], v[28:31], a[80:83], v[76:79]
    ds_write_b128 v16, a[236:239] offset:60992
    v_mfma_f32_16x16x32_bf16 v[80:83], v[172:175], a[28:31], v[80:83]
    v_lshl_or_b32 v168, v168, 2, v23
    v_lshlrev_b32 v168, 4, v168
    v_mfma_f32_16x16x32_bf16 v[88:91], v[24:27], a[52:55], v[88:91]
    v_bfe_u32 v23, v169, 2, 2
    v_xor_b32 v23, v23, v18
    v_mfma_f32_16x16x32_bf16 v[92:95], v[24:27], a[68:71], v[92:95]
    v_lshl_or_b32 v169, v169, 2, v23
    v_lshlrev_b32 v169, 4, v169
    v_mfma_f32_16x16x32_bf16 v[96:99], v[24:27], a[84:87], v[96:99]
    ds_write_b128 v16, a[244:247] offset:62016
    v_mfma_f32_16x16x32_bf16 v[100:103], v[172:175], a[44:47], v[100:103]
    v_bfe_u32 v23, v170, 2, 2
    v_xor_b32 v23, v23, v18
    v_mfma_f32_16x16x32_bf16 v[108:111], v[28:31], a[68:71], v[108:111]
    v_lshl_or_b32 v170, v170, 2, v23
    v_lshlrev_b32 v170, 4, v170
    v_mfma_f32_16x16x32_bf16 v[112:115], v[28:31], a[84:87], v[112:115]
    buffer_load_dword v12, v9, s[32:35], s78 offen sc1
    v_bfe_u32 v23, v171, 2, 2
    v_xor_b32 v23, v23, v18
    v_mfma_f32_16x16x32_bf16 v[116:119], v[172:175], a[60:63], v[116:119]
    ds_write_b128 v16, a[252:255] offset:63040
    v_mfma_f32_16x16x32_bf16 v[124:127], v[24:27], a[88:91], v[124:127]
    v_lshl_or_b32 v171, v171, 2, v23
    v_lshlrev_b32 v171, 4, v171
    v_mfma_f32_16x16x32_bf16 v[128:131], v[172:175], a[76:79], v[128:131]
    v_mfma_f32_16x16x32_bf16 v[136:139], v[172:175], a[92:95], v[136:139]
    s_waitcnt lgkmcnt(0)
    s_barrier
    ds_read_b128 a[0:3], v144 offset:0
    ds_read_b128 a[4:7], v144 offset:64064
    ds_read_b128 a[8:11], v145 offset:0
    ds_read_b128 a[12:15], v145 offset:64064
    ds_read_b128 a[16:19], v146 offset:0
    ds_read_b128 a[20:23], v146 offset:64064
    ds_read_b128 a[24:27], v147 offset:0
    ds_read_b128 a[28:31], v147 offset:64064
    ds_read_b128 a[32:35], v148 offset:0
    ds_read_b128 a[36:39], v148 offset:64064
    ds_read_b128 a[40:43], v149 offset:0
    ds_read_b128 a[44:47], v149 offset:64064
    ds_read_b128 a[48:51], v150 offset:0
    ds_read_b128 a[52:55], v150 offset:64064
    s_waitcnt lgkmcnt(12)
    v_mfma_f32_16x16x32_bf16 v[172:175], a[0:3], a[0:3], 0
    v_mfma_f32_16x16x32_bf16 v[172:175], a[4:7], a[4:7], v[172:175]
    s_waitcnt lgkmcnt(10)
    v_mfma_f32_16x16x32_bf16 v[176:179], a[0:3], a[8:11], 0
    v_mfma_f32_16x16x32_bf16 v[176:179], a[4:7], a[12:15], v[176:179]
    s_waitcnt lgkmcnt(8)
    v_mfma_f32_16x16x32_bf16 v[180:183], a[0:3], a[16:19], 0
    v_mfma_f32_16x16x32_bf16 v[180:183], a[4:7], a[20:23], v[180:183]
    s_mov_b32 s61, 200000
L_rx1:
    s_waitcnt vmcnt(0)
    v_cmp_ne_u32 vcc, 0, v12
    s_cbranch_vccz L_rx1done
    s_sleep 1
    buffer_load_dword v12, v9, s[32:35], s78 offen sc1
    s_sub_u32 s61, s61, 1
    s_cbranch_scc0 L_rx1
L_rx1done:
    s_waitcnt lgkmcnt(6)
    v_mfma_f32_16x16x32_bf16 v[184:187], a[0:3], a[24:27], 0
    v_fmac_f32 v188, v172, v32
    v_fmac_f32 v189, v173, v33
    v_mfma_f32_16x16x32_bf16 v[184:187], a[4:7], a[28:31], v[184:187]
    buffer_load_dwordx4 v[192:195], v2, s[32:35], s53 offen offset:0 sc1
    s_waitcnt lgkmcnt(4)
    v_fmac_f32 v188, v174, v34
    v_fmac_f32 v189, v175, v35
    v_mfma_f32_16x16x32_bf16 v[172:175], a[0:3], a[32:35], 0
    v_fmac_f32 v188, v176, v36
    v_fmac_f32 v189, v177, v37
    v_mfma_f32_16x16x32_bf16 v[172:175], a[4:7], a[36:39], v[172:175]
    buffer_load_dwordx4 v[196:199], v2, s[32:35], s53 offen offset:1024 sc1
    s_waitcnt lgkmcnt(2)
    v_fmac_f32 v188, v178, v38
    v_fmac_f32 v189, v179, v39
    v_mfma_f32_16x16x32_bf16 v[176:179], a[0:3], a[40:43], 0
    v_fmac_f32 v188, v180, v40
    v_fmac_f32 v189, v181, v41
    v_mfma_f32_16x16x32_bf16 v[176:179], a[4:7], a[44:47], v[176:179]
    buffer_load_dwordx4 v[200:203], v2, s[32:35], s53 offen offset:2048 sc1
    s_waitcnt lgkmcnt(0)
    v_fmac_f32 v188, v182, v42
    v_fmac_f32 v189, v183, v43
    v_mfma_f32_16x16x32_bf16 v[180:183], a[48:51], a[0:3], 0
    v_fmac_f32 v188, v184, v44
    v_fmac_f32 v189, v185, v45
    v_mfma_f32_16x16x32_bf16 v[180:183], a[52:55], a[4:7], v[180:183]
    buffer_load_dwordx4 v[204:207], v2, s[32:35], s53 offen offset:3072 sc1
    v_fmac_f32 v188, v186, v46
    v_fmac_f32 v189, v187, v47
    v_mfma_f32_16x16x32_bf16 v[184:187], a[8:11], a[8:11], 0
    ds_read_b128 a[56:59], v151 offset:0
    v_fmac_f32 v188, v172, v48
    v_fmac_f32 v189, v173, v49
    v_mfma_f32_16x16x32_bf16 v[184:187], a[12:15], a[12:15], v[184:187]
    buffer_load_dwordx4 v[208:211], v2, s[32:35], s54 offen offset:0 sc1
    v_fmac_f32 v188, v174, v50
    v_fmac_f32 v189, v175, v51
    v_mfma_f32_16x16x32_bf16 v[172:175], a[8:11], a[16:19], 0
    ds_read_b128 a[60:63], v151 offset:64064
    v_fmac_f32 v188, v176, v52
    v_fmac_f32 v189, v177, v53
    v_mfma_f32_16x16x32_bf16 v[172:175], a[12:15], a[20:23], v[172:175]
    buffer_load_dwordx4 v[212:215], v2, s[32:35], s54 offen offset:1024 sc1
    v_fmac_f32 v188, v178, v54
    v_fmac_f32 v189, v179, v55
    v_mfma_f32_16x16x32_bf16 v[176:179], a[8:11], a[24:27], 0
    ds_read_b128 a[64:67], v152 offset:0
    v_fmac_f32 v188, v180, v56
    v_mfma_f32_16x16x32_bf16 v[176:179], a[12:15], a[28:31], v[176:179]
    buffer_load_dwordx4 v[216:219], v2, s[32:35], s54 offen offset:2048 sc1
    v_mfma_f32_16x16x32_bf16 v[180:183], a[8:11], a[32:35], 0
    ds_read_b128 a[68:71], v152 offset:64064
    v_fmac_f32 v188, v184, v60
    v_fmac_f32 v189, v185, v61
    v_mfma_f32_16x16x32_bf16 v[180:183], a[12:15], a[36:39], v[180:183]
    buffer_load_dwordx4 v[220:223], v2, s[32:35], s54 offen offset:3072 sc1
    v_fmac_f32 v188, v186, v62
    v_fmac_f32 v189, v187, v63
    v_mfma_f32_16x16x32_bf16 v[184:187], a[8:11], a[40:43], 0
    ds_read_b128 a[72:75], v153 offset:0
    v_fmac_f32 v188, v172, v64
    v_fmac_f32 v189, v173, v65
    v_mfma_f32_16x16x32_bf16 v[184:187], a[12:15], a[44:47], v[184:187]
    v_fmac_f32 v188, v174, v66
    v_fmac_f32 v189, v175, v67
    v_mfma_f32_16x16x32_bf16 v[172:175], a[48:51], a[8:11], 0
    ds_read_b128 a[76:79], v153 offset:64064
    v_fmac_f32 v188, v176, v68
    v_fmac_f32 v189, v177, v69
    v_mfma_f32_16x16x32_bf16 v[172:175], a[52:55], a[12:15], v[172:175]
    v_fmac_f32 v188, v178, v70
    v_fmac_f32 v189, v179, v71
    v_mfma_f32_16x16x32_bf16 v[176:179], a[16:19], a[16:19], 0
    ds_read_b128 a[80:83], v154 offset:0
    v_fmac_f32 v188, v180, v72
    v_fmac_f32 v189, v181, v73
    v_mfma_f32_16x16x32_bf16 v[176:179], a[20:23], a[20:23], v[176:179]
    v_fmac_f32 v188, v182, v74
    v_fmac_f32 v189, v183, v75
    v_mfma_f32_16x16x32_bf16 v[180:183], a[16:19], a[24:27], 0
    ds_read_b128 a[84:87], v154 offset:64064
    v_fmac_f32 v188, v184, v76
    v_fmac_f32 v189, v185, v77
    v_mfma_f32_16x16x32_bf16 v[180:183], a[20:23], a[28:31], v[180:183]
    v_fmac_f32 v188, v186, v78
    v_fmac_f32 v189, v187, v79
    v_mfma_f32_16x16x32_bf16 v[184:187], a[16:19], a[32:35], 0
    ds_read_b128 a[88:91], v155 offset:0
    v_fmac_f32 v188, v172, v80
    v_mfma_f32_16x16x32_bf16 v[184:187], a[20:23], a[36:39], v[184:187]
    v_mfma_f32_16x16x32_bf16 v[172:175], a[16:19], a[40:43], 0
    ds_read_b128 a[92:95], v155 offset:64064
    v_fmac_f32 v188, v176, v84
    v_fmac_f32 v189, v177, v85
    v_mfma_f32_16x16x32_bf16 v[172:175], a[20:23], a[44:47], v[172:175]
    v_fmac_f32 v188, v178, v86
    v_fmac_f32 v189, v179, v87
    v_mfma_f32_16x16x32_bf16 v[176:179], a[48:51], a[16:19], 0
    ds_read_b128 a[96:99], v156 offset:0
    v_fmac_f32 v188, v180, v88
    v_fmac_f32 v189, v181, v89
    v_mfma_f32_16x16x32_bf16 v[176:179], a[52:55], a[20:23], v[176:179]
    v_fmac_f32 v188, v182, v90
    v_fmac_f32 v189, v183, v91
    v_mfma_f32_16x16x32_bf16 v[180:183], a[24:27], a[24:27], 0
    ds_read_b128 a[100:103], v156 offset:64064
    v_fmac_f32 v188, v184, v92
    v_fmac_f32 v189, v185, v93
    v_mfma_f32_16x16x32_bf16 v[180:183], a[28:31], a[28:31], v[180:183]
    v_fmac_f32 v188, v186, v94
    v_fmac_f32 v189, v187, v95
    v_mfma_f32_16x16x32_bf16 v[184:187], a[24:27], a[32:35], 0
    ds_read_b128 a[104:107], v157 offset:0
    v_fmac_f32 v188, v172, v96
    v_fmac_f32 v189, v173, v97
    v_mfma_f32_16x16x32_bf16 v[184:187], a[28:31], a[36:39], v[184:187]
    v_fmac_f32 v188, v174, v98
    v_fmac_f32 v189, v175, v99
    v_mfma_f32_16x16x32_bf16 v[172:175], a[24:27], a[40:43], 0
    ds_read_b128 a[108:111], v157 offset:64064
    v_fmac_f32 v188, v176, v100
    v_mfma_f32_16x16x32_bf16 v[172:175], a[28:31], a[44:47], v[172:175]
    v_mfma_f32_16x16x32_bf16 v[176:179], a[48:51], a[24:27], 0
    v_fmac_f32 v188, v180, v104
    v_fmac_f32 v189, v181, v105
    v_mfma_f32_16x16x32_bf16 v[176:179], a[52:55], a[28:31], v[176:179]
    v_fmac_f32 v188, v182, v106
    v_fmac_f32 v189, v183, v107
    v_mfma_f32_16x16x32_bf16 v[180:183], a[32:35], a[32:35], 0
    v_fmac_f32 v188, v184, v108
    v_fmac_f32 v189, v185, v109
    v_mfma_f32_16x16x32_bf16 v[180:183], a[36:39], a[36:39], v[180:183]
    v_fmac_f32 v188, v186, v110
    v_fmac_f32 v189, v187, v111
    v_mfma_f32_16x16x32_bf16 v[184:187], a[32:35], a[40:43], 0
    v_fmac_f32 v188, v172, v112
    v_fmac_f32 v189, v173, v113
    v_mfma_f32_16x16x32_bf16 v[184:187], a[36:39], a[44:47], v[184:187]
    v_fmac_f32 v188, v174, v114
    v_fmac_f32 v189, v175, v115
    v_mfma_f32_16x16x32_bf16 v[172:175], a[48:51], a[32:35], 0
    v_fmac_f32 v188, v176, v116
    v_mfma_f32_16x16x32_bf16 v[172:175], a[52:55], a[36:39], v[172:175]
    v_mfma_f32_16x16x32_bf16 v[176:179], a[40:43], a[40:43], 0
    v_fmac_f32 v188, v180, v120
    v_fmac_f32 v189, v181, v121
    v_mfma_f32_16x16x32_bf16 v[176:179], a[44:47], a[44:47], v[176:179]
    v_fmac_f32 v188, v182, v122
    v_fmac_f32 v189, v183, v123
    v_mfma_f32_16x16x32_bf16 v[180:183], a[48:51], a[40:43], 0
    v_fmac_f32 v188, v184, v124
    v_fmac_f32 v189, v185, v125
    v_mfma_f32_16x16x32_bf16 v[180:183], a[52:55], a[44:47], v[180:183]
    s_mov_b32 s12, 0xbdd2d3e8
    s_mov_b32 s13, 0xbdd2d3e8
    s_mov_b32 s14, 1.0
    s_mov_b32 s15, 1.0
    v_mov_b32 v23, v22
    s_waitcnt vmcnt(7)
    v_pk_add_f32 v[224:225], v[224:225], v[192:193]
    v_pk_add_f32 v[226:227], v[226:227], v[194:195]
    v_pk_mul_f32 v[12:13], v[224:225], v[224:225]
    v_pk_mul_f32 v[14:15], v[226:227], v[226:227]
    v_pk_fma_f32 v[12:13], v[12:13], s[12:13], v[22:23]
    v_pk_fma_f32 v[14:15], v[14:15], s[12:13], v[22:23]
    v_pk_mul_f32 v[12:13], v[12:13], v[224:225]
    v_pk_mul_f32 v[14:15], v[14:15], v[226:227]
    v_exp_f32 v12, v12
    v_exp_f32 v13, v13
    v_exp_f32 v14, v14
    v_exp_f32 v15, v15
    v_pk_mul_f32 v[224:225], v[224:225], s[72:73]
    v_pk_mul_f32 v[226:227], v[226:227], s[74:75]
    v_pk_add_f32 v[12:13], v[12:13], s[14:15]
    v_pk_add_f32 v[14:15], v[14:15], s[14:15]
    v_rcp_f32 v12, v12
    v_rcp_f32 v13, v13
    v_rcp_f32 v14, v14
    v_rcp_f32 v15, v15
    v_pk_mul_f32 v[224:225], v[224:225], v[12:13]
    v_pk_fma_f32 v[224:225], v[226:227], v[14:15], v[224:225]
    v_add_f32 v24, v224, v225
    buffer_store_dword v24, v20, s[32:35], s67 offen sc1
    s_add_u32 s67, s67, 167936
    s_waitcnt vmcnt(7)
    v_pk_add_f32 v[228:229], v[228:229], v[196:197]
    v_pk_add_f32 v[230:231], v[230:231], v[198:199]
    v_pk_mul_f32 v[4:5], v[228:229], v[228:229]
    v_pk_mul_f32 v[6:7], v[230:231], v[230:231]
    v_pk_fma_f32 v[4:5], v[4:5], s[12:13], v[22:23]
    v_pk_fma_f32 v[6:7], v[6:7], s[12:13], v[22:23]
    v_pk_mul_f32 v[4:5], v[4:5], v[228:229]
    v_pk_mul_f32 v[6:7], v[6:7], v[230:231]
    v_exp_f32 v4, v4
    v_exp_f32 v5, v5
    v_exp_f32 v6, v6
    v_exp_f32 v7, v7
    v_pk_mul_f32 v[228:229], v[228:229], s[72:73]
    v_pk_mul_f32 v[230:231], v[230:231], s[74:75]
    v_pk_add_f32 v[4:5], v[4:5], s[14:15]
    v_pk_add_f32 v[6:7], v[6:7], s[14:15]
    v_rcp_f32 v4, v4
    v_rcp_f32 v5, v5
    v_rcp_f32 v6, v6
    v_rcp_f32 v7, v7
    v_pk_mul_f32 v[228:229], v[228:229], v[4:5]
    v_pk_fma_f32 v[228:229], v[230:231], v[6:7], v[228:229]
    v_add_f32 v25, v228, v229
    buffer_store_dword v25, v20, s[32:35], s67 offen sc1
    s_add_u32 s67, s67, 167936
    s_waitcnt vmcnt(7)
    v_pk_add_f32 v[232:233], v[232:233], v[200:201]
    v_pk_add_f32 v[234:235], v[234:235], v[202:203]
    v_pk_mul_f32 v[12:13], v[232:233], v[232:233]
    v_pk_mul_f32 v[14:15], v[234:235], v[234:235]
    v_pk_fma_f32 v[12:13], v[12:13], s[12:13], v[22:23]
    v_pk_fma_f32 v[14:15], v[14:15], s[12:13], v[22:23]
    v_pk_mul_f32 v[12:13], v[12:13], v[232:233]
    v_pk_mul_f32 v[14:15], v[14:15], v[234:235]
    v_exp_f32 v12, v12
    v_exp_f32 v13, v13
    v_exp_f32 v14, v14
    v_exp_f32 v15, v15
    v_pk_mul_f32 v[232:233], v[232:233], s[72:73]
    v_pk_mul_f32 v[234:235], v[234:235], s[74:75]
    v_pk_add_f32 v[12:13], v[12:13], s[14:15]
    v_pk_add_f32 v[14:15], v[14:15], s[14:15]
    v_rcp_f32 v12, v12
    v_rcp_f32 v13, v13
    v_rcp_f32 v14, v14
    v_rcp_f32 v15, v15
    v_pk_mul_f32 v[232:233], v[232:233], v[12:13]
    v_pk_fma_f32 v[232:233], v[234:235], v[14:15], v[232:233]
    v_add_f32 v26, v232, v233
    buffer_store_dword v26, v20, s[32:35], s67 offen sc1
    s_add_u32 s67, s67, 167936
    s_waitcnt vmcnt(7)
    v_pk_add_f32 v[236:237], v[236:237], v[204:205]
    v_pk_add_f32 v[238:239], v[238:239], v[206:207]
    v_pk_mul_f32 v[4:5], v[236:237], v[236:237]
    v_pk_mul_f32 v[6:7], v[238:239], v[238:239]
    v_pk_fma_f32 v[4:5], v[4:5], s[12:13], v[22:23]
    v_pk_fma_f32 v[6:7], v[6:7], s[12:13], v[22:23]
    v_pk_mul_f32 v[4:5], v[4:5], v[236:237]
    v_pk_mul_f32 v[6:7], v[6:7], v[238:239]
    v_exp_f32 v4, v4
    v_exp_f32 v5, v5
    v_exp_f32 v6, v6
    v_exp_f32 v7, v7
    v_pk_mul_f32 v[236:237], v[236:237], s[72:73]
    v_pk_mul_f32 v[238:239], v[238:239], s[74:75]
    v_pk_add_f32 v[4:5], v[4:5], s[14:15]
    v_pk_add_f32 v[6:7], v[6:7], s[14:15]
    v_rcp_f32 v4, v4
    v_rcp_f32 v5, v5
    v_rcp_f32 v6, v6
    v_rcp_f32 v7, v7
    v_pk_mul_f32 v[236:237], v[236:237], v[4:5]
    v_pk_fma_f32 v[236:237], v[238:239], v[6:7], v[236:237]
    v_add_f32 v27, v236, v237
    buffer_store_dword v27, v20, s[32:35], s67 offen sc1
    s_add_u32 s67, s67, 167936
    s_waitcnt vmcnt(7)
    v_pk_add_f32 v[240:241], v[240:241], v[208:209]
    v_pk_add_f32 v[242:243], v[242:243], v[210:211]
    v_pk_mul_f32 v[12:13], v[240:241], v[240:241]
    v_pk_mul_f32 v[14:15], v[242:243], v[242:243]
    v_pk_fma_f32 v[12:13], v[12:13], s[12:13], v[22:23]
    v_pk_fma_f32 v[14:15], v[14:15], s[12:13], v[22:23]
    v_pk_mul_f32 v[12:13], v[12:13], v[240:241]
    v_pk_mul_f32 v[14:15], v[14:15], v[242:243]
    v_exp_f32 v12, v12
    v_exp_f32 v13, v13
    v_exp_f32 v14, v14
    v_exp_f32 v15, v15
    v_pk_mul_f32 v[240:241], v[240:241], s[72:73]
    v_pk_mul_f32 v[242:243], v[242:243], s[74:75]
    v_pk_add_f32 v[12:13], v[12:13], s[14:15]
    v_pk_add_f32 v[14:15], v[14:15], s[14:15]
    v_rcp_f32 v12, v12
    v_rcp_f32 v13, v13
    v_rcp_f32 v14, v14
    v_rcp_f32 v15, v15
    v_pk_mul_f32 v[240:241], v[240:241], v[12:13]
    v_pk_fma_f32 v[240:241], v[242:243], v[14:15], v[240:241]
    v_add_f32 v28, v240, v241
    buffer_store_dword v28, v20, s[32:35], s67 offen sc1
    s_add_u32 s67, s67, 167936
    s_waitcnt vmcnt(7)
    v_pk_add_f32 v[244:245], v[244:245], v[212:213]
    v_pk_add_f32 v[246:247], v[246:247], v[214:215]
    v_pk_mul_f32 v[4:5], v[244:245], v[244:245]
    v_pk_mul_f32 v[6:7], v[246:247], v[246:247]
    v_pk_fma_f32 v[4:5], v[4:5], s[12:13], v[22:23]
    v_pk_fma_f32 v[6:7], v[6:7], s[12:13], v[22:23]
    v_pk_mul_f32 v[4:5], v[4:5], v[244:245]
    v_pk_mul_f32 v[6:7], v[6:7], v[246:247]
    v_exp_f32 v4, v4
    v_exp_f32 v5, v5
    v_exp_f32 v6, v6
    v_exp_f32 v7, v7
    v_pk_mul_f32 v[244:245], v[244:245], s[72:73]
    v_pk_mul_f32 v[246:247], v[246:247], s[74:75]
    v_pk_add_f32 v[4:5], v[4:5], s[14:15]
    v_pk_add_f32 v[6:7], v[6:7], s[14:15]
    v_rcp_f32 v4, v4
    v_rcp_f32 v5, v5
    v_rcp_f32 v6, v6
    v_rcp_f32 v7, v7
    v_pk_mul_f32 v[244:245], v[244:245], v[4:5]
    v_pk_fma_f32 v[244:245], v[246:247], v[6:7], v[244:245]
    v_add_f32 v29, v244, v245
    buffer_store_dword v29, v20, s[32:35], s67 offen sc1
    s_add_u32 s67, s67, 167936
    s_waitcnt vmcnt(7)
    v_pk_add_f32 v[248:249], v[248:249], v[216:217]
    v_pk_add_f32 v[250:251], v[250:251], v[218:219]
    v_pk_mul_f32 v[12:13], v[248:249], v[248:249]
    v_pk_mul_f32 v[14:15], v[250:251], v[250:251]
    v_pk_fma_f32 v[12:13], v[12:13], s[12:13], v[22:23]
    v_pk_fma_f32 v[14:15], v[14:15], s[12:13], v[22:23]
    v_pk_mul_f32 v[12:13], v[12:13], v[248:249]
    v_pk_mul_f32 v[14:15], v[14:15], v[250:251]
    v_exp_f32 v12, v12
    v_exp_f32 v13, v13
    v_exp_f32 v14, v14
    v_exp_f32 v15, v15
    v_pk_mul_f32 v[248:249], v[248:249], s[72:73]
    v_pk_mul_f32 v[250:251], v[250:251], s[74:75]
    v_pk_add_f32 v[12:13], v[12:13], s[14:15]
    v_pk_add_f32 v[14:15], v[14:15], s[14:15]
    v_rcp_f32 v12, v12
    v_rcp_f32 v13, v13
    v_rcp_f32 v14, v14
    v_rcp_f32 v15, v15
    v_pk_mul_f32 v[248:249], v[248:249], v[12:13]
    v_pk_fma_f32 v[248:249], v[250:251], v[14:15], v[248:249]
    v_add_f32 v30, v248, v249
    buffer_store_dword v30, v20, s[32:35], s67 offen sc1
    s_add_u32 s67, s67, 167936
    s_waitcnt vmcnt(7)
    v_pk_add_f32 v[252:253], v[252:253], v[220:221]
    v_pk_add_f32 v[254:255], v[254:255], v[222:223]
    v_pk_mul_f32 v[4:5], v[252:253], v[252:253]
    v_pk_mul_f32 v[6:7], v[254:255], v[254:255]
    v_pk_fma_f32 v[4:5], v[4:5], s[12:13], v[22:23]
    v_pk_fma_f32 v[6:7], v[6:7], s[12:13], v[22:23]
    v_pk_mul_f32 v[4:5], v[4:5], v[252:253]
    v_pk_mul_f32 v[6:7], v[6:7], v[254:255]
    v_exp_f32 v4, v4
    v_exp_f32 v5, v5
    v_exp_f32 v6, v6
    v_exp_f32 v7, v7
    v_pk_mul_f32 v[252:253], v[252:253], s[72:73]
    v_pk_mul_f32 v[254:255], v[254:255], s[74:75]
    v_pk_add_f32 v[4:5], v[4:5], s[14:15]
    v_pk_add_f32 v[6:7], v[6:7], s[14:15]
    v_rcp_f32 v4, v4
    v_rcp_f32 v5, v5
    v_rcp_f32 v6, v6
    v_rcp_f32 v7, v7
    v_pk_mul_f32 v[252:253], v[252:253], v[4:5]
    v_pk_fma_f32 v[252:253], v[254:255], v[6:7], v[252:253]
    v_add_f32 v31, v252, v253
    buffer_store_dword v31, v20, s[32:35], s67 offen sc1
    s_add_u32 s67, s67, 167936
    v_lshlrev_b32 v250, 2, v2
    s_lshl_b32 s53, s48, 4
    s_add_u32 s53, s53, s65
    s_add_u32 s53, s53, 32768
    s_add_u32 s54, s53, 4096
    v_fmac_f32 v188, v186, v126
    v_fmac_f32 v189, v187, v127
    v_mfma_f32_16x16x32_bf16 v[184:187], a[48:51], a[48:51], 0
    v_fmac_f32 v188, v172, v128
    v_mfma_f32_16x16x32_bf16 v[184:187], a[52:55], a[52:55], v[184:187]
    s_waitcnt lgkmcnt(12)
    v_mfma_f32_16x16x32_bf16 v[172:175], a[56:59], a[56:59], 0
    v_fmac_f32 v188, v176, v132
    v_fmac_f32 v189, v177, v133
    v_mfma_f32_16x16x32_bf16 v[172:175], a[60:63], a[60:63], v[172:175]
    s_waitcnt lgkmcnt(10)
    v_fmac_f32 v188, v178, v134
    v_fmac_f32 v189, v179, v135
    v_mfma_f32_16x16x32_bf16 v[176:179], a[56:59], a[64:67], 0
    v_fmac_f32 v188, v180, v136
    v_mfma_f32_16x16x32_bf16 v[176:179], a[60:63], a[68:71], v[176:179]
    s_waitcnt lgkmcnt(8)
    v_mfma_f32_16x16x32_bf16 v[180:183], a[56:59], a[72:75], 0
    v_fmac_f32 v188, v184, v140
    v_mfma_f32_16x16x32_bf16 v[180:183], a[60:63], a[76:79], v[180:183]
    s_waitcnt lgkmcnt(6)
    v_mfma_f32_16x16x32_bf16 v[184:187], a[56:59], a[80:83], 0
    v_fmac_f32 v190, v172, v32
    v_fmac_f32 v191, v173, v33
    v_mfma_f32_16x16x32_bf16 v[184:187], a[60:63], a[84:87], v[184:187]
    s_waitcnt lgkmcnt(4)
    v_fmac_f32 v190, v174, v34
    v_fmac_f32 v191, v175, v35
    v_mfma_f32_16x16x32_bf16 v[172:175], a[56:59], a[88:91], 0
    v_fmac_f32 v190, v176, v36
    v_fmac_f32 v191, v177, v37
    v_mfma_f32_16x16x32_bf16 v[172:175], a[60:63], a[92:95], v[172:175]
    s_waitcnt lgkmcnt(2)
    v_fmac_f32 v190, v178, v38
    v_fmac_f32 v191, v179, v39
    v_mfma_f32_16x16x32_bf16 v[176:179], a[56:59], a[96:99], 0
    v_fmac_f32 v190, v180, v40
    v_fmac_f32 v191, v181, v41
    v_mfma_f32_16x16x32_bf16 v[176:179], a[60:63], a[100:103], v[176:179]
    s_waitcnt lgkmcnt(0)
    v_fmac_f32 v190, v182, v42
    v_fmac_f32 v191, v183, v43
    v_mfma_f32_16x16x32_bf16 v[180:183], a[104:107], a[56:59], 0
    v_fmac_f32 v190, v184, v44
    v_fmac_f32 v191, v185, v45
    v_mfma_f32_16x16x32_bf16 v[180:183], a[108:111], a[60:63], v[180:183]
    v_fmac_f32 v190, v186, v46
    v_fmac_f32 v191, v187, v47
    v_mfma_f32_16x16x32_bf16 v[184:187], a[64:67], a[64:67], 0
    ds_read_b128 a[0:3], v158 offset:0
    v_fmac_f32 v190, v172, v48
    v_fmac_f32 v191, v173, v49
    v_mfma_f32_16x16x32_bf16 v[184:187], a[68:71], a[68:71], v[184:187]
    v_fmac_f32 v190, v174, v50
    v_fmac_f32 v191, v175, v51
    v_mfma_f32_16x16x32_bf16 v[172:175], a[64:67], a[72:75], 0
    ds_read_b128 a[4:7], v158 offset:64064
    v_fmac_f32 v190, v176, v52
    v_fmac_f32 v191, v177, v53
    v_mfma_f32_16x16x32_bf16 v[172:175], a[68:71], a[76:79], v[172:175]
    v_fmac_f32 v190, v178, v54
    v_fmac_f32 v191, v179, v55
    v_mfma_f32_16x16x32_bf16 v[176:179], a[64:67], a[80:83], 0
    ds_read_b128 a[8:11], v159 offset:0
    v_fmac_f32 v190, v180, v56
    v_mfma_f32_16x16x32_bf16 v[176:179], a[68:71], a[84:87], v[176:179]
    v_mfma_f32_16x16x32_bf16 v[180:183], a[64:67], a[88:91], 0
    ds_read_b128 a[12:15], v159 offset:64064
    v_fmac_f32 v190, v184, v60
    v_fmac_f32 v191, v185, v61
    v_mfma_f32_16x16x32_bf16 v[180:183], a[68:71], a[92:95], v[180:183]
    v_fmac_f32 v190, v186, v62
    v_fmac_f32 v191, v187, v63
    v_mfma_f32_16x16x32_bf16 v[184:187], a[64:67], a[96:99], 0
    ds_read_b128 a[16:19], v160 offset:0
    v_fmac_f32 v190, v172, v64
    v_fmac_f32 v191, v173, v65
    v_mfma_f32_16x16x32_bf16 v[184:187], a[68:71], a[100:103], v[184:187]
    v_fmac_f32 v190, v174, v66
    v_fmac_f32 v191, v175, v67
    v_mfma_f32_16x16x32_bf16 v[172:175], a[104:107], a[64:67], 0
    ds_read_b128 a[20:23], v160 offset:64064
    v_fmac_f32 v190, v176, v68
    v_fmac_f32 v191, v177, v69
    v_mfma_f32_16x16x32_bf16 v[172:175], a[108:111], a[68:71], v[172:175]
    v_fmac_f32 v190, v178, v70
    v_fmac_f32 v191, v179, v71
    v_mfma_f32_16x16x32_bf16 v[176:179], a[72:75], a[72:75], 0
    ds_read_b128 a[24:27], v161 offset:0
    v_fmac_f32 v190, v180, v72
    v_fmac_f32 v191, v181, v73
    v_mfma_f32_16x16x32_bf16 v[176:179], a[76:79], a[76:79], v[176:179]
    v_fmac_f32 v190, v182, v74
    v_fmac_f32 v191, v183, v75
    v_mfma_f32_16x16x32_bf16 v[180:183], a[72:75], a[80:83], 0
    ds_read_b128 a[28:31], v161 offset:64064
    v_fmac_f32 v190, v184, v76
    v_fmac_f32 v191, v185, v77
    v_mfma_f32_16x16x32_bf16 v[180:183], a[76:79], a[84:87], v[180:183]
    v_fmac_f32 v190, v186, v78
    v_fmac_f32 v191, v187, v79
    v_mfma_f32_16x16x32_bf16 v[184:187], a[72:75], a[88:91], 0
    ds_read_b128 a[32:35], v162 offset:0
    v_fmac_f32 v190, v172, v80
    v_mfma_f32_16x16x32_bf16 v[184:187], a[76:79], a[92:95], v[184:187]
    v_mfma_f32_16x16x32_bf16 v[172:175], a[72:75], a[96:99], 0
    ds_read_b128 a[36:39], v162 offset:64064
    v_fmac_f32 v190, v176, v84
    v_fmac_f32 v191, v177, v85
    v_mfma_f32_16x16x32_bf16 v[172:175], a[76:79], a[100:103], v[172:175]
    v_fmac_f32 v190, v178, v86
    v_fmac_f32 v191, v179, v87
    v_mfma_f32_16x16x32_bf16 v[176:179], a[104:107], a[72:75], 0
    ds_read_b128 a[40:43], v163 offset:0
    v_fmac_f32 v190, v180, v88
    v_fmac_f32 v191, v181, v89
    v_mfma_f32_16x16x32_bf16 v[176:179], a[108:111], a[76:79], v[176:179]
    v_fmac_f32 v190, v182, v90
    v_fmac_f32 v191, v183, v91
    v_mfma_f32_16x16x32_bf16 v[180:183], a[80:83], a[80:83], 0
    ds_read_b128 a[44:47], v163 offset:64064
    v_fmac_f32 v190, v184, v92
    v_fmac_f32 v191, v185, v93
    v_mfma_f32_16x16x32_bf16 v[180:183], a[84:87], a[84:87], v[180:183]
    v_fmac_f32 v190, v186, v94
    v_fmac_f32 v191, v187, v95
    v_mfma_f32_16x16x32_bf16 v[184:187], a[80:83], a[88:91], 0
    ds_read_b128 a[48:51], v164 offset:0
    v_fmac_f32 v190, v172, v96
    v_fmac_f32 v191, v173, v97
    v_mfma_f32_16x16x32_bf16 v[184:187], a[84:87], a[92:95], v[184:187]
    v_fmac_f32 v190, v174, v98
    v_fmac_f32 v191, v175, v99
    v_mfma_f32_16x16x32_bf16 v[172:175], a[80:83], a[96:99], 0
    ds_read_b128 a[52:55], v164 offset:64064
    v_fmac_f32 v190, v176, v100
    v_mfma_f32_16x16x32_bf16 v[172:175], a[84:87], a[100:103], v[172:175]
    v_mfma_f32_16x16x32_bf16 v[176:179], a[104:107], a[80:83], 0
    v_fmac_f32 v190, v180, v104
    v_fmac_f32 v191, v181, v105
    v_mfma_f32_16x16x32_bf16 v[176:179], a[108:111], a[84:87], v[176:179]
    v_fmac_f32 v190, v182, v106
    v_fmac_f32 v191, v183, v107
    v_mfma_f32_16x16x32_bf16 v[180:183], a[88:91], a[88:91], 0
    v_fmac_f32 v190, v184, v108
    v_fmac_f32 v191, v185, v109
    v_mfma_f32_16x16x32_bf16 v[180:183], a[92:95], a[92:95], v[180:183]
    v_fmac_f32 v190, v186, v110
    v_fmac_f32 v191, v187, v111
    v_mfma_f32_16x16x32_bf16 v[184:187], a[88:91], a[96:99], 0
    v_fmac_f32 v190, v172, v112
    v_fmac_f32 v191, v173, v113
    v_mfma_f32_16x16x32_bf16 v[184:187], a[92:95], a[100:103], v[184:187]
    v_fmac_f32 v190, v174, v114
    v_fmac_f32 v191, v175, v115
    v_mfma_f32_16x16x32_bf16 v[172:175], a[104:107], a[88:91], 0
    v_fmac_f32 v190, v176, v116
    v_mfma_f32_16x16x32_bf16 v[172:175], a[108:111], a[92:95], v[172:175]
    v_mfma_f32_16x16x32_bf16 v[176:179], a[96:99], a[96:99], 0
    v_fmac_f32 v190, v180, v120
    v_fmac_f32 v191, v181, v121
    v_mfma_f32_16x16x32_bf16 v[176:179], a[100:103], a[100:103], v[176:179]
    v_fmac_f32 v190, v182, v122
    v_fmac_f32 v191, v183, v123
    v_mfma_f32_16x16x32_bf16 v[180:183], a[104:107], a[96:99], 0
    v_fmac_f32 v190, v184, v124
    v_fmac_f32 v191, v185, v125
    v_mfma_f32_16x16x32_bf16 v[180:183], a[108:111], a[100:103], v[180:183]
    v_fmac_f32 v190, v186, v126
    v_fmac_f32 v191, v187, v127
    v_mfma_f32_16x16x32_bf16 v[184:187], a[104:107], a[104:107], 0
    v_fmac_f32 v190, v172, v128
    v_mfma_f32_16x16x32_bf16 v[184:187], a[108:111], a[108:111], v[184:187]
    s_waitcnt lgkmcnt(12)
    v_mfma_f32_16x16x32_bf16 v[172:175], a[0:3], a[0:3], 0
    v_fmac_f32 v190, v176, v132
    v_fmac_f32 v191, v177, v133
    v_mfma_f32_16x16x32_bf16 v[172:175], a[4:7], a[4:7], v[172:175]
    s_waitcnt lgkmcnt(10)
    v_fmac_f32 v190, v178, v134
    v_fmac_f32 v191, v179, v135
    v_mfma_f32_16x16x32_bf16 v[176:179], a[0:3], a[8:11], 0
    v_fmac_f32 v190, v180, v136
    v_mfma_f32_16x16x32_bf16 v[176:179], a[4:7], a[12:15], v[176:179]
    s_waitcnt lgkmcnt(8)
    v_mfma_f32_16x16x32_bf16 v[180:183], a[0:3], a[16:19], 0
    v_fmac_f32 v190, v184, v140
    v_mfma_f32_16x16x32_bf16 v[180:183], a[4:7], a[20:23], v[180:183]
    s_waitcnt lgkmcnt(6)
    v_mfma_f32_16x16x32_bf16 v[184:187], a[0:3], a[24:27], 0
    v_fmac_f32 v1, v172, v32
    v_fmac_f32 v3, v173, v33
    v_mfma_f32_16x16x32_bf16 v[184:187], a[4:7], a[28:31], v[184:187]
    s_waitcnt lgkmcnt(4)
    v_fmac_f32 v1, v174, v34
    v_fmac_f32 v3, v175, v35
    v_mfma_f32_16x16x32_bf16 v[172:175], a[0:3], a[32:35], 0
    v_fmac_f32 v1, v176, v36
    v_fmac_f32 v3, v177, v37
    v_mfma_f32_16x16x32_bf16 v[172:175], a[4:7], a[36:39], v[172:175]
    s_waitcnt lgkmcnt(2)
    v_fmac_f32 v1, v178, v38
    v_fmac_f32 v3, v179, v39
    v_mfma_f32_16x16x32_bf16 v[176:179], a[0:3], a[40:43], 0
    v_fmac_f32 v1, v180, v40
    v_fmac_f32 v3, v181, v41
    v_mfma_f32_16x16x32_bf16 v[176:179], a[4:7], a[44:47], v[176:179]
    s_waitcnt lgkmcnt(0)
    v_fmac_f32 v1, v182, v42
    v_fmac_f32 v3, v183, v43
    v_mfma_f32_16x16x32_bf16 v[180:183], a[48:51], a[0:3], 0
    v_fmac_f32 v1, v184, v44
    v_fmac_f32 v3, v185, v45
    v_mfma_f32_16x16x32_bf16 v[180:183], a[52:55], a[4:7], v[180:183]
    v_fmac_f32 v1, v186, v46
    v_fmac_f32 v3, v187, v47
    v_mfma_f32_16x16x32_bf16 v[184:187], a[8:11], a[8:11], 0
    ds_read_b128 a[56:59], v165 offset:0
    v_fmac_f32 v1, v172, v48
    v_fmac_f32 v3, v173, v49
    v_mfma_f32_16x16x32_bf16 v[184:187], a[12:15], a[12:15], v[184:187]
    v_fmac_f32 v1, v174, v50
    v_fmac_f32 v3, v175, v51
    v_mfma_f32_16x16x32_bf16 v[172:175], a[8:11], a[16:19], 0
    ds_read_b128 a[60:63], v165 offset:64064
    v_fmac_f32 v1, v176, v52
    v_fmac_f32 v3, v177, v53
    v_mfma_f32_16x16x32_bf16 v[172:175], a[12:15], a[20:23], v[172:175]
    v_fmac_f32 v1, v178, v54
    v_fmac_f32 v3, v179, v55
    v_mfma_f32_16x16x32_bf16 v[176:179], a[8:11], a[24:27], 0
    ds_read_b128 a[64:67], v166 offset:0
    v_fmac_f32 v1, v180, v56
    v_mfma_f32_16x16x32_bf16 v[176:179], a[12:15], a[28:31], v[176:179]
    v_mfma_f32_16x16x32_bf16 v[180:183], a[8:11], a[32:35], 0
    ds_read_b128 a[68:71], v166 offset:64064
    v_fmac_f32 v1, v184, v60
    v_fmac_f32 v3, v185, v61
    v_mfma_f32_16x16x32_bf16 v[180:183], a[12:15], a[36:39], v[180:183]
    v_fmac_f32 v1, v186, v62
    v_fmac_f32 v3, v187, v63
    v_mfma_f32_16x16x32_bf16 v[184:187], a[8:11], a[40:43], 0
    ds_read_b128 a[72:75], v167 offset:0
    v_fmac_f32 v1, v172, v64
    v_fmac_f32 v3, v173, v65
    v_mfma_f32_16x16x32_bf16 v[184:187], a[12:15], a[44:47], v[184:187]
    v_fmac_f32 v1, v174, v66
    v_fmac_f32 v3, v175, v67
    v_mfma_f32_16x16x32_bf16 v[172:175], a[48:51], a[8:11], 0
    ds_read_b128 a[76:79], v167 offset:64064
    v_fmac_f32 v1, v176, v68
    v_fmac_f32 v3, v177, v69
    v_mfma_f32_16x16x32_bf16 v[172:175], a[52:55], a[12:15], v[172:175]
    v_fmac_f32 v1, v178, v70
    v_fmac_f32 v3, v179, v71
    v_mfma_f32_16x16x32_bf16 v[176:179], a[16:19], a[16:19], 0
    ds_read_b128 a[80:83], v168 offset:0
    v_fmac_f32 v1, v180, v72
    v_fmac_f32 v3, v181, v73
    v_mfma_f32_16x16x32_bf16 v[176:179], a[20:23], a[20:23], v[176:179]
    v_fmac_f32 v1, v182, v74
    v_fmac_f32 v3, v183, v75
    v_mfma_f32_16x16x32_bf16 v[180:183], a[16:19], a[24:27], 0
    ds_read_b128 a[84:87], v168 offset:64064
    v_fmac_f32 v1, v184, v76
    v_fmac_f32 v3, v185, v77
    v_mfma_f32_16x16x32_bf16 v[180:183], a[20:23], a[28:31], v[180:183]
    v_fmac_f32 v1, v186, v78
    v_fmac_f32 v3, v187, v79
    v_mfma_f32_16x16x32_bf16 v[184:187], a[16:19], a[32:35], 0
    ds_read_b128 a[88:91], v169 offset:0
    v_fmac_f32 v1, v172, v80
    v_mfma_f32_16x16x32_bf16 v[184:187], a[20:23], a[36:39], v[184:187]
    v_mfma_f32_16x16x32_bf16 v[172:175], a[16:19], a[40:43], 0
    ds_read_b128 a[92:95], v169 offset:64064
    v_fmac_f32 v1, v176, v84
    v_fmac_f32 v3, v177, v85
    v_mfma_f32_16x16x32_bf16 v[172:175], a[20:23], a[44:47], v[172:175]
    v_fmac_f32 v1, v178, v86
    v_fmac_f32 v3, v179, v87
    v_mfma_f32_16x16x32_bf16 v[176:179], a[48:51], a[16:19], 0
    ds_read_b128 a[96:99], v170 offset:0
    v_fmac_f32 v1, v180, v88
    v_fmac_f32 v3, v181, v89
    v_mfma_f32_16x16x32_bf16 v[176:179], a[52:55], a[20:23], v[176:179]
    v_fmac_f32 v1, v182, v90
    v_fmac_f32 v3, v183, v91
    v_mfma_f32_16x16x32_bf16 v[180:183], a[24:27], a[24:27], 0
    ds_read_b128 a[100:103], v170 offset:64064
    v_fmac_f32 v1, v184, v92
    v_fmac_f32 v3, v185, v93
    v_mfma_f32_16x16x32_bf16 v[180:183], a[28:31], a[28:31], v[180:183]
    v_fmac_f32 v1, v186, v94
    v_fmac_f32 v3, v187, v95
    v_mfma_f32_16x16x32_bf16 v[184:187], a[24:27], a[32:35], 0
    ds_read_b128 a[104:107], v171 offset:0
    v_fmac_f32 v1, v172, v96
    v_fmac_f32 v3, v173, v97
    v_mfma_f32_16x16x32_bf16 v[184:187], a[28:31], a[36:39], v[184:187]
    v_fmac_f32 v1, v174, v98
    v_fmac_f32 v3, v175, v99
    v_mfma_f32_16x16x32_bf16 v[172:175], a[24:27], a[40:43], 0
    ds_read_b128 a[108:111], v171 offset:64064
    v_fmac_f32 v1, v176, v100
    v_mfma_f32_16x16x32_bf16 v[172:175], a[28:31], a[44:47], v[172:175]
    v_mfma_f32_16x16x32_bf16 v[176:179], a[48:51], a[24:27], 0
    v_fmac_f32 v1, v180, v104
    v_fmac_f32 v3, v181, v105
    v_mfma_f32_16x16x32_bf16 v[176:179], a[52:55], a[28:31], v[176:179]
    v_fmac_f32 v1, v182, v106
    v_fmac_f32 v3, v183, v107
    v_mfma_f32_16x16x32_bf16 v[180:183], a[32:35], a[32:35], 0
    v_fmac_f32 v1, v184, v108
    v_fmac_f32 v3, v185, v109
    v_mfma_f32_16x16x32_bf16 v[180:183], a[36:39], a[36:39], v[180:183]
    v_fmac_f32 v1, v186, v110
    v_fmac_f32 v3, v187, v111
    v_mfma_f32_16x16x32_bf16 v[184:187], a[32:35], a[40:43], 0
    v_fmac_f32 v1, v172, v112
    v_fmac_f32 v3, v173, v113
    v_mfma_f32_16x16x32_bf16 v[184:187], a[36:39], a[44:47], v[184:187]
    v_fmac_f32 v1, v174, v114
    v_fmac_f32 v3, v175, v115
    v_mfma_f32_16x16x32_bf16 v[172:175], a[48:51], a[32:35], 0
    v_fmac_f32 v1, v176, v116
    v_mfma_f32_16x16x32_bf16 v[172:175], a[52:55], a[36:39], v[172:175]
    v_mfma_f32_16x16x32_bf16 v[176:179], a[40:43], a[40:43], 0
    v_fmac_f32 v1, v180, v120
    v_fmac_f32 v3, v181, v121
    v_mfma_f32_16x16x32_bf16 v[176:179], a[44:47], a[44:47], v[176:179]
    v_fmac_f32 v1, v182, v122
    v_fmac_f32 v3, v183, v123
    v_mfma_f32_16x16x32_bf16 v[180:183], a[48:51], a[40:43], 0
    v_fmac_f32 v1, v184, v124
    v_fmac_f32 v3, v185, v125
    v_mfma_f32_16x16x32_bf16 v[180:183], a[52:55], a[44:47], v[180:183]
    v_fmac_f32 v1, v186, v126
    v_fmac_f32 v3, v187, v127
    v_mfma_f32_16x16x32_bf16 v[184:187], a[48:51], a[48:51], 0
    v_fmac_f32 v1, v172, v128
    v_mfma_f32_16x16x32_bf16 v[184:187], a[52:55], a[52:55], v[184:187]
    s_waitcnt lgkmcnt(12)
    v_mfma_f32_16x16x32_bf16 v[172:175], a[56:59], a[56:59], 0
    v_fmac_f32 v1, v176, v132
    v_fmac_f32 v3, v177, v133
    v_mfma_f32_16x16x32_bf16 v[172:175], a[60:63], a[60:63], v[172:175]
    s_waitcnt lgkmcnt(10)
    v_fmac_f32 v1, v178, v134
    v_fmac_f32 v3, v179, v135
    v_mfma_f32_16x16x32_bf16 v[176:179], a[56:59], a[64:67], 0
    v_fmac_f32 v1, v180, v136
    v_mfma_f32_16x16x32_bf16 v[176:179], a[60:63], a[68:71], v[176:179]
    s_waitcnt lgkmcnt(8)
    v_mfma_f32_16x16x32_bf16 v[180:183], a[56:59], a[72:75], 0
    v_fmac_f32 v1, v184, v140
    v_mfma_f32_16x16x32_bf16 v[180:183], a[60:63], a[76:79], v[180:183]
    s_waitcnt lgkmcnt(6)
    v_mfma_f32_16x16x32_bf16 v[184:187], a[56:59], a[80:83], 0
    v_fmac_f32 v8, v172, v32
    v_fmac_f32 v10, v173, v33
    v_mfma_f32_16x16x32_bf16 v[184:187], a[60:63], a[84:87], v[184:187]
    s_waitcnt lgkmcnt(4)
    v_fmac_f32 v8, v174, v34
    v_fmac_f32 v10, v175, v35
    v_mfma_f32_16x16x32_bf16 v[172:175], a[56:59], a[88:91], 0
    v_fmac_f32 v8, v176, v36
    v_fmac_f32 v10, v177, v37
    v_mfma_f32_16x16x32_bf16 v[172:175], a[60:63], a[92:95], v[172:175]
    s_waitcnt lgkmcnt(2)
    v_fmac_f32 v8, v178, v38
    v_fmac_f32 v10, v179, v39
    v_mfma_f32_16x16x32_bf16 v[176:179], a[56:59], a[96:99], 0
    v_fmac_f32 v8, v180, v40
    v_fmac_f32 v10, v181, v41
    v_mfma_f32_16x16x32_bf16 v[176:179], a[60:63], a[100:103], v[176:179]
    s_waitcnt lgkmcnt(0)
    v_fmac_f32 v8, v182, v42
    v_fmac_f32 v10, v183, v43
    v_mfma_f32_16x16x32_bf16 v[180:183], a[104:107], a[56:59], 0
    v_fmac_f32 v8, v184, v44
    v_fmac_f32 v10, v185, v45
    v_mfma_f32_16x16x32_bf16 v[180:183], a[108:111], a[60:63], v[180:183]
    buffer_load_dwordx4 v[232:235], v250, s[32:35], s53 offen sc1
    buffer_load_dwordx4 v[236:239], v250, s[32:35], s54 offen sc1
    v_fmac_f32 v8, v186, v46
    v_fmac_f32 v10, v187, v47
    v_mfma_f32_16x16x32_bf16 v[184:187], a[64:67], a[64:67], 0
    v_fmac_f32 v8, v172, v48
    v_fmac_f32 v10, v173, v49
    v_mfma_f32_16x16x32_bf16 v[184:187], a[68:71], a[68:71], v[184:187]
    v_fmac_f32 v8, v174, v50
    v_fmac_f32 v10, v175, v51
    v_mfma_f32_16x16x32_bf16 v[172:175], a[64:67], a[72:75], 0
    v_fmac_f32 v8, v176, v52
    v_fmac_f32 v10, v177, v53
    v_mfma_f32_16x16x32_bf16 v[172:175], a[68:71], a[76:79], v[172:175]
    v_fmac_f32 v8, v178, v54
    v_fmac_f32 v10, v179, v55
    v_mfma_f32_16x16x32_bf16 v[176:179], a[64:67], a[80:83], 0
    v_fmac_f32 v8, v180, v56
    v_mfma_f32_16x16x32_bf16 v[176:179], a[68:71], a[84:87], v[176:179]
    v_mfma_f32_16x16x32_bf16 v[180:183], a[64:67], a[88:91], 0
    v_fmac_f32 v8, v184, v60
    v_fmac_f32 v10, v185, v61
    v_mfma_f32_16x16x32_bf16 v[180:183], a[68:71], a[92:95], v[180:183]
    v_fmac_f32 v8, v186, v62
    v_fmac_f32 v10, v187, v63
    v_mfma_f32_16x16x32_bf16 v[184:187], a[64:67], a[96:99], 0
    v_fmac_f32 v8, v172, v64
    v_fmac_f32 v10, v173, v65
    v_mfma_f32_16x16x32_bf16 v[184:187], a[68:71], a[100:103], v[184:187]
    v_fmac_f32 v8, v174, v66
    v_fmac_f32 v10, v175, v67
    v_mfma_f32_16x16x32_bf16 v[172:175], a[104:107], a[64:67], 0
    v_fmac_f32 v8, v176, v68
    v_fmac_f32 v10, v177, v69
    v_mfma_f32_16x16x32_bf16 v[172:175], a[108:111], a[68:71], v[172:175]
    v_fmac_f32 v8, v178, v70
    v_fmac_f32 v10, v179, v71
    v_mfma_f32_16x16x32_bf16 v[176:179], a[72:75], a[72:75], 0
    v_fmac_f32 v8, v180, v72
    v_fmac_f32 v10, v181, v73
    v_mfma_f32_16x16x32_bf16 v[176:179], a[76:79], a[76:79], v[176:179]
    v_fmac_f32 v8, v182, v74
    v_fmac_f32 v10, v183, v75
    v_mfma_f32_16x16x32_bf16 v[180:183], a[72:75], a[80:83], 0
    v_fmac_f32 v8, v184, v76
    v_fmac_f32 v10, v185, v77
    v_mfma_f32_16x16x32_bf16 v[180:183], a[76:79], a[84:87], v[180:183]
    v_fmac_f32 v8, v186, v78
    v_fmac_f32 v10, v187, v79
    v_mfma_f32_16x16x32_bf16 v[184:187], a[72:75], a[88:91], 0
    v_fmac_f32 v8, v172, v80
    v_mfma_f32_16x16x32_bf16 v[184:187], a[76:79], a[92:95], v[184:187]
    v_mfma_f32_16x16x32_bf16 v[172:175], a[72:75], a[96:99], 0
    v_fmac_f32 v8, v176, v84
    v_fmac_f32 v10, v177, v85
    v_mfma_f32_16x16x32_bf16 v[172:175], a[76:79], a[100:103], v[172:175]
    v_fmac_f32 v8, v178, v86
    v_fmac_f32 v10, v179, v87
    v_mfma_f32_16x16x32_bf16 v[176:179], a[104:107], a[72:75], 0
    v_fmac_f32 v8, v180, v88
    v_fmac_f32 v10, v181, v89
    v_mfma_f32_16x16x32_bf16 v[176:179], a[108:111], a[76:79], v[176:179]
    v_fmac_f32 v8, v182, v90
    v_fmac_f32 v10, v183, v91
    v_mfma_f32_16x16x32_bf16 v[180:183], a[80:83], a[80:83], 0
    v_fmac_f32 v8, v184, v92
    v_fmac_f32 v10, v185, v93
    v_mfma_f32_16x16x32_bf16 v[180:183], a[84:87], a[84:87], v[180:183]
    v_fmac_f32 v8, v186, v94
    v_fmac_f32 v10, v187, v95
    v_mfma_f32_16x16x32_bf16 v[184:187], a[80:83], a[88:91], 0
    v_fmac_f32 v8, v172, v96
    v_fmac_f32 v10, v173, v97
    v_mfma_f32_16x16x32_bf16 v[184:187], a[84:87], a[92:95], v[184:187]
    v_fmac_f32 v8, v174, v98
    v_fmac_f32 v10, v175, v99
    v_mfma_f32_16x16x32_bf16 v[172:175], a[80:83], a[96:99], 0
    v_fmac_f32 v8, v176, v100
    v_mfma_f32_16x16x32_bf16 v[172:175], a[84:87], a[100:103], v[172:175]
    v_mfma_f32_16x16x32_bf16 v[176:179], a[104:107], a[80:83], 0
    v_fmac_f32 v8, v180, v104
    v_fmac_f32 v10, v181, v105
    v_mfma_f32_16x16x32_bf16 v[176:179], a[108:111], a[84:87], v[176:179]
    v_fmac_f32 v8, v182, v106
    v_fmac_f32 v10, v183, v107
    v_mfma_f32_16x16x32_bf16 v[180:183], a[88:91], a[88:91], 0
    v_fmac_f32 v8, v184, v108
    v_fmac_f32 v10, v185, v109
    v_mfma_f32_16x16x32_bf16 v[180:183], a[92:95], a[92:95], v[180:183]
    v_fmac_f32 v8, v186, v110
    v_fmac_f32 v10, v187, v111
    v_mfma_f32_16x16x32_bf16 v[184:187], a[88:91], a[96:99], 0
    v_fmac_f32 v8, v172, v112
    v_fmac_f32 v10, v173, v113
    v_mfma_f32_16x16x32_bf16 v[184:187], a[92:95], a[100:103], v[184:187]
    v_fmac_f32 v8, v174, v114
    v_fmac_f32 v10, v175, v115
    v_mfma_f32_16x16x32_bf16 v[172:175], a[104:107], a[88:91], 0
    v_fmac_f32 v8, v176, v116
    v_mfma_f32_16x16x32_bf16 v[172:175], a[108:111], a[92:95], v[172:175]
    v_mfma_f32_16x16x32_bf16 v[176:179], a[96:99], a[96:99], 0
    v_fmac_f32 v8, v180, v120
    v_fmac_f32 v10, v181, v121
    v_mfma_f32_16x16x32_bf16 v[176:179], a[100:103], a[100:103], v[176:179]
    v_fmac_f32 v8, v182, v122
    v_fmac_f32 v10, v183, v123
    v_mfma_f32_16x16x32_bf16 v[180:183], a[104:107], a[96:99], 0
    v_fmac_f32 v8, v184, v124
    v_fmac_f32 v10, v185, v125
    v_mfma_f32_16x16x32_bf16 v[180:183], a[108:111], a[100:103], v[180:183]
    v_fmac_f32 v8, v186, v126
    v_fmac_f32 v10, v187, v127
    v_mfma_f32_16x16x32_bf16 v[184:187], a[104:107], a[104:107], 0
    v_fmac_f32 v8, v172, v128
    v_mfma_f32_16x16x32_bf16 v[184:187], a[108:111], a[108:111], v[184:187]
    v_fmac_f32 v8, v176, v132
    v_fmac_f32 v10, v177, v133
    v_fmac_f32 v8, v178, v134
    v_fmac_f32 v10, v179, v135
    v_fmac_f32 v8, v180, v136
    s_nop 2
    v_fmac_f32 v8, v184, v140
    s_mov_b32 s61, 200000
L_rx2:
    s_waitcnt vmcnt(0)
    v_max3_u32 v20, v232, v233, v234
    v_max3_u32 v20, v20, v235, v236
    v_max3_u32 v20, v20, v237, v238
    v_max_u32 v20, v20, v239
    v_cmp_eq_u32 vcc, -1, v20
    s_cbranch_vccz L_rx2done
    s_sleep 1
    buffer_load_dwordx4 v[232:235], v250, s[32:35], s53 offen sc1
    buffer_load_dwordx4 v[236:239], v250, s[32:35], s54 offen sc1
    s_sub_u32 s61, s61, 1
    s_cbranch_scc0 L_rx2
L_rx2done:
    v_add_f32 v232, v232, v236
    v_add_f32 v236, v188, v189
    v_add_f32 v233, v233, v237
    v_add_f32 v237, v190, v191
    v_add_f32 v234, v234, v238
    v_add_f32 v238, v1, v3
    v_add_f32 v235, v235, v239
    v_add_f32 v239, v8, v10
    v_add_f32_dpp v232, v232, v232 row_shr:1 row_mask:0xf bank_mask:0xf
    v_add_f32_dpp v233, v233, v233 row_shr:1 row_mask:0xf bank_mask:0xf
    v_add_f32_dpp v234, v234, v234 row_shr:1 row_mask:0xf bank_mask:0xf
    v_add_f32_dpp v235, v235, v235 row_shr:1 row_mask:0xf bank_mask:0xf
    v_add_f32_dpp v236, v236, v236 row_shr:1 row_mask:0xf bank_mask:0xf
    v_add_f32_dpp v237, v237, v237 row_shr:1 row_mask:0xf bank_mask:0xf
    v_add_f32_dpp v238, v238, v238 row_shr:1 row_mask:0xf bank_mask:0xf
    v_add_f32_dpp v239, v239, v239 row_shr:1 row_mask:0xf bank_mask:0xf
    v_add_f32_dpp v232, v232, v232 row_shr:2 row_mask:0xf bank_mask:0xf
    v_add_f32_dpp v233, v233, v233 row_shr:2 row_mask:0xf bank_mask:0xf
    v_add_f32_dpp v234, v234, v234 row_shr:2 row_mask:0xf bank_mask:0xf
    v_add_f32_dpp v235, v235, v235 row_shr:2 row_mask:0xf bank_mask:0xf
    v_add_f32_dpp v236, v236, v236 row_shr:2 row_mask:0xf bank_mask:0xf
    v_add_f32_dpp v237, v237, v237 row_shr:2 row_mask:0xf bank_mask:0xf
    v_add_f32_dpp v238, v238, v238 row_shr:2 row_mask:0xf bank_mask:0xf
    v_add_f32_dpp v239, v239, v239 row_shr:2 row_mask:0xf bank_mask:0xf
    v_add_f32_dpp v232, v232, v232 row_shr:4 row_mask:0xf bank_mask:0xf
    v_add_f32_dpp v233, v233, v233 row_shr:4 row_mask:0xf bank_mask:0xf
    v_add_f32_dpp v234, v234, v234 row_shr:4 row_mask:0xf bank_mask:0xf
    v_add_f32_dpp v235, v235, v235 row_shr:4 row_mask:0xf bank_mask:0xf
    v_add_f32_dpp v236, v236, v236 row_shr:4 row_mask:0xf bank_mask:0xf
    v_add_f32_dpp v237, v237, v237 row_shr:4 row_mask:0xf bank_mask:0xf
    v_add_f32_dpp v238, v238, v238 row_shr:4 row_mask:0xf bank_mask:0xf
    v_add_f32_dpp v239, v239, v239 row_shr:4 row_mask:0xf bank_mask:0xf
    v_add_f32_dpp v232, v232, v232 row_shr:8 row_mask:0xf bank_mask:0xf
    v_add_f32_dpp v233, v233, v233 row_shr:8 row_mask:0xf bank_mask:0xf
    v_add_f32_dpp v234, v234, v234 row_shr:8 row_mask:0xf bank_mask:0xf
    v_add_f32_dpp v235, v235, v235 row_shr:8 row_mask:0xf bank_mask:0xf
    v_add_f32_dpp v236, v236, v236 row_shr:8 row_mask:0xf bank_mask:0xf
    v_add_f32_dpp v237, v237, v237 row_shr:8 row_mask:0xf bank_mask:0xf
    v_add_f32_dpp v238, v238, v238 row_shr:8 row_mask:0xf bank_mask:0xf
    v_add_f32_dpp v239, v239, v239 row_shr:8 row_mask:0xf bank_mask:0xf
    v_add_f32_dpp v232, v232, v232 row_bcast:15 row_mask:0xa bank_mask:0xf
    v_add_f32_dpp v233, v233, v233 row_bcast:15 row_mask:0xa bank_mask:0xf
    v_add_f32_dpp v234, v234, v234 row_bcast:15 row_mask:0xa bank_mask:0xf
    v_add_f32_dpp v235, v235, v235 row_bcast:15 row_mask:0xa bank_mask:0xf
    v_add_f32_dpp v236, v236, v236 row_bcast:15 row_mask:0xa bank_mask:0xf
    v_add_f32_dpp v237, v237, v237 row_bcast:15 row_mask:0xa bank_mask:0xf
    v_add_f32_dpp v238, v238, v238 row_bcast:15 row_mask:0xa bank_mask:0xf
    v_add_f32_dpp v239, v239, v239 row_bcast:15 row_mask:0xa bank_mask:0xf
    v_add_f32_dpp v232, v232, v232 row_bcast:31 row_mask:0xc bank_mask:0xf
    v_add_f32_dpp v233, v233, v233 row_bcast:31 row_mask:0xc bank_mask:0xf
    v_add_f32_dpp v234, v234, v234 row_bcast:31 row_mask:0xc bank_mask:0xf
    v_add_f32_dpp v235, v235, v235 row_bcast:31 row_mask:0xc bank_mask:0xf
    v_add_f32_dpp v236, v236, v236 row_bcast:31 row_mask:0xc bank_mask:0xf
    v_add_f32_dpp v237, v237, v237 row_bcast:31 row_mask:0xc bank_mask:0xf
    v_add_f32_dpp v238, v238, v238 row_bcast:31 row_mask:0xc bank_mask:0xf
    v_add_f32_dpp v239, v239, v239 row_bcast:31 row_mask:0xc bank_mask:0xf
    v_add_f32 v236, s4, v236
    v_add_f32 v237, s5, v237
    v_add_f32 v238, s6, v238
    v_add_f32 v239, s7, v239
    v_cvt_pk_bf16_f32 v232, v232, v236
    v_cvt_pk_bf16_f32 v233, v233, v237
    v_cvt_pk_bf16_f32 v234, v234, v238
    v_cvt_pk_bf16_f32 v235, v235, v239
    v_and_b32 v236, 0xffff0000, v232
    v_lshlrev_b32 v232, 16, v232
    v_and_b32 v237, 0xffff0000, v233
    v_lshlrev_b32 v233, 16, v233
    v_and_b32 v238, 0xffff0000, v234
    v_lshlrev_b32 v234, 16, v234
    v_and_b32 v239, 0xffff0000, v235
    v_lshlrev_b32 v235, 16, v235
    v_add_f32 v232, s76, v232
    v_add_f32 v233, s76, v233
    v_add_f32 v234, s76, v234
    v_add_f32 v235, s76, v235
    v_cvt_pk_bf16_f32 v240, v232, v233
    v_cvt_pk_bf16_f32 v242, v234, v235
    v_lshlrev_b32 v232, 16, v240
    v_and_b32 v233, 0xffff0000, v240
    v_lshlrev_b32 v234, 16, v242
    v_and_b32 v235, 0xffff0000, v242
    v_add_f32 v232, v232, v236
    v_add_f32 v233, v233, v237
    v_add_f32 v234, v234, v238
    v_add_f32 v235, v235, v239
    v_cvt_pk_bf16_f32 v240, v232, v233
    v_cvt_pk_bf16_f32 v241, v234, v235
    s_lshl_b32 s51, s2, 5
    s_lshl_b32 s52, s48, 3
    s_add_u32 s51, s51, s52
    s_mov_b32 exec_lo, 0
    s_mov_b32 exec_hi, 0x80000000
    buffer_store_dwordx2 v[240:241], v9, s[44:47], s51 offen
L_end:
    s_endpgm
.section .rodata,"a"
.p2align 6
.amdhsa_kernel standalone__deep_cross_pnn__recsys_kernel
  .amdhsa_next_free_vgpr 512
  .amdhsa_next_free_sgpr 102
  .amdhsa_accum_offset 256
  .amdhsa_group_segment_fixed_size 0
  .amdhsa_kernarg_size 80
  .amdhsa_user_sgpr_count 2
  .amdhsa_user_sgpr_kernarg_segment_ptr 1
  .amdhsa_system_sgpr_workgroup_id_x 1
.end_amdhsa_kernel
```
